```python
import torch

def _softmax(x, axis=-1):
    return torch.softmax(x, dim=axis)
def _gelu(x):
    return torch.nn.functional.gelu(x, approximate="tanh")
def _silu(x):
    return torch.nn.functional.silu(x)
def _sigmoid(x):
    return torch.sigmoid(x)
def _layernorm(x, axis=-1, eps=1e-5):
    m = x.mean(dim=axis, keepdim=True)
    v = x.var(dim=axis, keepdim=True, unbiased=False)
    return (x - m) / torch.sqrt(v + eps)
def _scatter_add(tgt, idx, src, axis=0):
    return tgt.clone().index_add_(axis, idx, src)
def _segment_sum(src, seg, n):
    out = torch.zeros((n,) + src.shape[1:], dtype=src.dtype)
    return out.index_add_(0, seg, src)
def _pad(x, pw):
    flat = tuple(v for pair in reversed(pw) for v in pair)
    return torch.nn.functional.pad(x, flat)

kernel_name = 'concat_heads__linear_attn_block__softmax_full_mha__prompt'

def setup_inputs():

    _w = (lambda a: (lambda t: t.to(torch.bfloat16) if t.is_floating_point() else t)(torch.as_tensor(a)))
    def _A_setup():
        B, S, D = 1, 2048, 1024
        return {
            "x": _w((lambda *s: torch.randn(*s, dtype=torch.bfloat16) * 0.05)(B, S, D)),
            "wqkv": _w((lambda *s: torch.randn(*s, dtype=torch.bfloat16) * 1.6)(D, 3 * D)),
            "wo": _w((lambda *s: torch.randn(*s, dtype=torch.bfloat16) * 0.1)(D, D)),
        }
    _A_in = _A_setup()

    def _B_setup():
        B, S, D = 1, 2048, 1024
        return {
            "x": _w((lambda *s: torch.randn(*s, dtype=torch.bfloat16) * 0.2)(B, S, D)),
            "wqkv": _w((lambda *s: torch.randn(*s, dtype=torch.bfloat16) * 0.2)(D, 3 * D)),
            "wo": _w((lambda *s: torch.randn(*s, dtype=torch.bfloat16) * 0.05)(D, D)),
        }
    _B_in = _B_setup()

    return {
        "A_x": _A_in["x"],
        "A_wqkv": _A_in["wqkv"],
        "A_wo": _A_in["wo"],
        "B_x": _B_in["x"],
        "B_wqkv": _B_in["wqkv"],
        "B_wo": _B_in["wo"],
    }

def reference(A_x, A_wqkv, A_wo, B_x, B_wqkv, B_wo):
    def _A_ref(x, wqkv, wo):
        B, S, D = x.shape
        H = 32; Dh = D // H
        qkv = (lambda x, *d: x.permute(*d))((x @ wqkv).reshape(B, S, 3, H, Dh), 2, 0, 3, 1, 4)
        q, k, v = qkv[0], qkv[1], qkv[2]
        phi = lambda t: torch.where(t > 0, t + 1, torch.exp(t)) + 1e-6
        pq, pk = phi(q), phi(k)
        kv = torch.einsum("bhsd,bhse->bhde", pk, v)
        z = torch.einsum("bhsd->bhd", pk)
        num = torch.einsum("bhqd,bhde->bhqe", pq, kv)
        den = torch.einsum("bhqd,bhd->bhq", pq, z)[..., None] + 1e-6
        o = num / den
        return (lambda x, *d: x.permute(*d))(o, 0, 2, 1, 3).reshape(B, S, D) @ wo

    def _B_ref(x, wqkv, wo):
        B, S, D = x.shape
        H = 32; Dh = D // H
        qkv = (lambda x, *d: x.permute(*d))((x @ wqkv).reshape(B, S, 3, H, Dh), 2, 0, 3, 1, 4)
        q, k, v = qkv[0], qkv[1], qkv[2]
        scale = Dh ** -0.5
        scores = torch.einsum("bhqd,bhkd->bhqk", q, k) * scale
        p = _softmax(scores, axis=-1)
        o = torch.einsum("bhqk,bhkd->bhqd", p, v)
        return (lambda x, *d: x.permute(*d))(o, 0, 2, 1, 3).reshape(B, S, D) @ wo

    a = _A_ref(A_x, A_wqkv, A_wo)
    b = _B_ref(B_x, B_wqkv, B_wo)
    return torch.concatenate([a, b], axis=-1)
```

```asm
; @launch grid=(256,1,1) block=(512,1,1) lds=163840
.amdgcn_target "amdgcn-amd-amdhsa--gfx950"
.text
.p2align 12
.text
.globl concat_heads__linear_attn_block__softmax_full_mha__prompt_kernel
.p2align 8
.type concat_heads__linear_attn_block__softmax_full_mha__prompt_kernel,@function
concat_heads__linear_attn_block__softmax_full_mha__prompt_kernel:
    s_cmp_ge_u32 s2, 256
    s_cbranch_scc1 L_end
    s_load_dwordx4 s[4:7], s[0:1], 0
    s_load_dwordx2 s[8:9], s[0:1], 24
    s_load_dwordx2 s[10:11], s[0:1], 32
    s_load_dwordx4 s[12:15], s[0:1], 56
    s_load_dwordx2 s[62:63], s[0:1], 16
    s_load_dwordx4 s[96:99], s[0:1], 40
    v_lshrrev_b32 v2, 6, v0
    v_and_b32 v1, 63, v0
    s_and_b32 s38, s2, 7
    v_readfirstlane_b32 s31, v2
    s_lshr_b32 s39, s2, 3
    s_and_b32 s28, s39, 1
    s_and_b32 s42, s38, 1
    s_lshl_b32 s42, s42, 2
    s_bfe_u32 s43, s39, 0x20001
    s_add_u32 s29, s42, s43
    s_lshr_b32 s42, s38, 1
    s_lshl_b32 s42, s42, 2
    s_lshr_b32 s43, s39, 3
    s_add_u32 s30, s42, s43
    s_mov_b32 s55, 3
    s_sub_u32 s47, 15, s55
    s_and_b32 s32, s31, 3
    s_lshr_b32 s33, s31, 2
    s_mov_b32 s36, 0
    s_mov_b32 s53, 0x10000
    s_mov_b32 s37, 0
    s_lshl_b32 s34, s32, 13
    s_add_u32 s34, s34, 61440
    s_mul_i32 s35, s32, 3072
    v_lshrrev_b32 v2, 3, v1
    v_and_b32 v3, 7, v1
    v_lshrrev_b32 v4, 4, v1
    v_xor_b32 v5, v3, v4
    v_lshlrev_b32 v5, 4, v5
    v_lshl_add_u32 v5, v2, 11, v5
    s_lshl_b32 s40, s29, 19
    s_lshl_b32 s41, s32, 17
    s_add_u32 s40, s40, s41
    v_add_u32 v8, s40, v5
    v_xor_b32 v6, 64, v8
    v_add_u32 v9, 15360, v6
    v_add_u32 v10, 30720, v8
    v_add_u32 v11, 46080, v6
    s_movk_i32 s42, 6144
    v_mul_u32_u24 v7, s42, v2
    v_and_b32 v4, 1, v4
    v_lshlrev_b32 v4, 1, v4
    v_xor_b32 v4, v4, v3
    s_and_b32 s40, s32, 1
    s_lshl_b32 s40, s40, 2
    v_xor_b32 v4, s40, v4
    v_lshl_add_u32 v7, v4, 4, v7
    s_mul_i32 s40, s32, 49152
    s_and_b32 s41, s30, s47
    s_lshl_b32 s41, s41, 7
    s_add_u32 s40, s40, s41
    s_and_b32 s41, s30, s55
    s_lshl_b32 s41, s41, 7
    s_add_u32 s41, s41, s40
    v_add_u32 v12, s41, v7
    s_add_u32 s41, s30, 1
    s_and_b32 s41, s41, s55
    s_lshl_b32 s41, s41, 7
    s_add_u32 s41, s41, s40
    s_add_u32 s41, s41, 1024
    v_add_u32 v13, s41, v7
    s_add_u32 s41, s30, 1
    s_add_u32 s41, s41, s28
    s_and_b32 s41, s41, s55
    s_lshl_b32 s41, s41, 7
    s_add_u32 s41, s41, s40
    s_add_u32 s41, s41, 2048
    v_add_u32 v14, s41, v7
    s_waitcnt lgkmcnt(0)
    s_cmp_eq_u32 s28, 0
    s_cselect_b32 s16, s4, s8
    s_cselect_b32 s17, s5, s9
    s_mov_b32 s18, 0x400000
    s_mov_b32 s19, 0x20000
    s_cselect_b32 s20, s6, s10
    s_cselect_b32 s21, s7, s11
    s_mov_b32 s22, 0x600000
    s_mov_b32 s23, 0x20000
    s_cmp_lg_u32 s33, 0
    s_cbranch_scc1 L_k1_noload
    s_add_u32 m0, s34, 0
    s_nop 0
    buffer_load_dwordx4 v8, s[16:19], s36 offen offset:0  lds
    buffer_load_dwordx4 v9, s[16:19], s36 offen offset:1024  lds
    buffer_load_dwordx4 v10, s[16:19], s36 offen offset:2048  lds
    buffer_load_dwordx4 v11, s[16:19], s36 offen offset:3072  lds
    s_add_u32 m0, s34, 4096
    s_nop 0
    buffer_load_dwordx4 v8, s[16:19], s53 offen offset:0  lds
    buffer_load_dwordx4 v9, s[16:19], s53 offen offset:1024  lds
    buffer_load_dwordx4 v10, s[16:19], s53 offen offset:2048  lds
    buffer_load_dwordx4 v11, s[16:19], s53 offen offset:3072  lds
    s_add_u32 s36, s36, 128
    s_cmp_ge_u32 s36, 2048
    s_cselect_b32 s36, 0x40000000, s36
    s_add_u32 s53, s36, 0x10000
    s_add_u32 m0, s35, 0
    s_nop 0
    buffer_load_dwordx4 v12, s[20:23], s37 offen offset:0  lds
    buffer_load_dwordx4 v13, s[20:23], s37 offen offset:1024  lds
    buffer_load_dwordx4 v14, s[20:23], s37 offen offset:2048  lds
    s_add_u32 s37, s37, 196608
    s_add_u32 m0, s35, 12288
    s_nop 0
    buffer_load_dwordx4 v12, s[20:23], s37 offen offset:0  lds
    buffer_load_dwordx4 v13, s[20:23], s37 offen offset:1024  lds
    buffer_load_dwordx4 v14, s[20:23], s37 offen offset:2048  lds
    s_add_u32 s37, s37, 196608
    s_add_u32 m0, s34, 32768
    s_nop 0
    buffer_load_dwordx4 v8, s[16:19], s36 offen offset:0  lds
    buffer_load_dwordx4 v9, s[16:19], s36 offen offset:1024  lds
    buffer_load_dwordx4 v10, s[16:19], s36 offen offset:2048  lds
    buffer_load_dwordx4 v11, s[16:19], s36 offen offset:3072  lds
    s_add_u32 m0, s34, 36864
    s_nop 0
    buffer_load_dwordx4 v8, s[16:19], s53 offen offset:0  lds
    buffer_load_dwordx4 v9, s[16:19], s53 offen offset:1024  lds
    buffer_load_dwordx4 v10, s[16:19], s53 offen offset:2048  lds
    buffer_load_dwordx4 v11, s[16:19], s53 offen offset:3072  lds
    s_add_u32 s36, s36, 128
    s_cmp_ge_u32 s36, 2048
    s_cselect_b32 s36, 0x40000000, s36
    s_add_u32 s53, s36, 0x10000
    s_add_u32 m0, s35, 24576
    s_nop 0
    buffer_load_dwordx4 v12, s[20:23], s37 offen offset:0  lds
    buffer_load_dwordx4 v13, s[20:23], s37 offen offset:1024  lds
    buffer_load_dwordx4 v14, s[20:23], s37 offen offset:2048  lds
    s_add_u32 s37, s37, 196608
    s_add_u32 m0, s35, 36864
    s_nop 0
    buffer_load_dwordx4 v12, s[20:23], s37 offen offset:0  lds
    buffer_load_dwordx4 v13, s[20:23], s37 offen offset:1024  lds
    buffer_load_dwordx4 v14, s[20:23], s37 offen offset:2048  lds
    s_add_u32 s37, s37, 196608
    s_setprio 1
L_k1_noload:
    s_mov_b32 s24, s14
    s_mov_b32 s25, s15
    s_mov_b32 s26, 0x2000000
    s_mov_b32 s27, 0x20000
    s_lshl_b32 s40, s2, 3
    s_add_u32 s40, s40, s31
    s_cmp_eq_u32 s40, 4
    s_cbranch_scc0 L_p1_notag
    v_mov_b32 v7, 19005440
    buffer_load_dword v236, v7, s[24:27], 0 offen sc1
L_p1_notag:
    s_lshl_b32 s60, s28, 4
    s_add_u32 s60, s60, s30
    s_lshl_b32 s60, s60, 3
    s_add_u32 s60, s60, s29
    s_lshl_b32 s60, s60, 7
    s_add_u32 s60, s60, 18874368
    s_mov_b32 s61, s28
    s_mov_b32 s14, 256
    s_mov_b32 s15, 0x20000
    v_and_b32 v2, 15, v1
    v_lshrrev_b32 v3, 4, v1
    v_bfe_u32 v4, v1, 1, 3
    v_xor_b32 v4, v4, v3
    v_lshlrev_b32 v5, 7, v2
    v_add_u32 v5, s34, v5
    v_lshl_add_u32 v15, v4, 4, v5
    v_xor_b32 v16, 64, v15
    v_bfe_u32 v4, v1, 2, 2
    v_mul_u32_u24 v5, 3072, v3
    v_lshl_add_u32 v5, v4, 7, v5
    v_bfe_u32 v4, v1, 3, 2
    s_lshl_b32 s40, s33, 1
    v_xor_b32 v4, s40, v4
    v_lshl_add_u32 v5, v4, 5, v5
    v_and_b32 v4, 3, v1
    v_lshl_add_u32 v17, v4, 3, v5
    v_xor_b32 v18, 32, v17
    v_lshlrev_b32 v6, 4, v2
    v_lshl_add_u32 v6, v3, 9, v6
    s_mov_b32 s48, 0
    s_mov_b32 s49, 32768
    s_mov_b32 s50, 24576
    s_mov_b32 s44, 0xffff4000
    s_mov_b32 s45, 12288
    s_mov_b32 s52, 14
    s_getpc_b64 s[56:57]
L_k1_pc:
    s_sub_u32 s56, s56, L_k1_pc-concat_heads__linear_attn_block__softmax_full_mha__prompt_kernel
    s_subb_u32 s57, s57, 0
    s_mov_b32 s58, L_code_end-concat_heads__linear_attn_block__softmax_full_mha__prompt_kernel
    s_mov_b32 s59, 0x20000
    s_lshl_b32 s40, s39, 2
    s_add_u32 s40, s40, s32
    s_lshl_b32 s40, s40, 8
    v_lshlrev_b32 v7, 7, v1
    v_add_u32 v7, s40, v7
    s_lshl_b32 s40, s28, 1
    s_add_u32 s40, s40, s33
    s_cmp_eq_u32 s40, 1
    s_cbranch_scc1 L_k1_A1
    s_cmp_eq_u32 s40, 2
    s_cbranch_scc1 L_k1_B0
    s_cmp_eq_u32 s40, 3
    s_cbranch_scc1 L_k1_B1
    s_waitcnt vmcnt(14)
    s_barrier
    ds_read_b128 v[60:63], v15 offset:0
    ds_read_b128 v[64:67], v15 offset:2048
    ds_read_b128 v[68:71], v15 offset:4096
    ds_read_b128 v[72:75], v15 offset:6144
    ds_read_b64_tr_b16 v[76:77], v17 offset:0
    ds_read_b64_tr_b16 v[78:79], v17 offset:512
    ds_read_b64_tr_b16 v[80:81], v18 offset:0
    ds_read_b64_tr_b16 v[82:83], v18 offset:512
    ds_read_b64_tr_b16 v[84:85], v17 offset:1024
    ds_read_b64_tr_b16 v[86:87], v17 offset:1536
    ds_read_b64_tr_b16 v[88:89], v18 offset:1024
    ds_read_b64_tr_b16 v[90:91], v18 offset:1536
    ds_read_b64_tr_b16 v[92:93], v17 offset:2048
    ds_read_b64_tr_b16 v[94:95], v17 offset:2560
    ds_read_b64_tr_b16 v[96:97], v18 offset:2048
    ds_read_b64_tr_b16 v[98:99], v18 offset:2560
    s_add_u32 m0, s34, 65536
    s_nop 0
    buffer_load_dwordx4 v8, s[16:19], s36 offen offset:0  lds
    buffer_load_dwordx4 v9, s[16:19], s36 offen offset:1024  lds
    s_mov_b32 s54, 0
    s_waitcnt lgkmcnt(0)
    v_mfma_f32_16x16x32_bf16 v[140:143], v[76:79], v[60:63], 0
    ds_read_b128 v[20:23], v16 offset:0
    buffer_load_dwordx4 v10, s[16:19], s36 offen offset:2048  lds
    v_mfma_f32_16x16x32_bf16 v[144:147], v[80:83], v[60:63], 0
    ds_read_b128 v[24:27], v16 offset:2048
    v_mfma_f32_16x16x32_bf16 v[152:155], v[80:83], v[64:67], 0
    ds_read_b128 v[28:31], v16 offset:4096
    buffer_load_dwordx4 v11, s[16:19], s36 offen offset:3072  lds
    v_mfma_f32_16x16x32_bf16 v[148:151], v[76:79], v[64:67], 0
    ds_read_b128 v[32:35], v16 offset:6144
    v_mfma_f32_16x16x32_bf16 v[156:159], v[76:79], v[68:71], 0
    ds_read_b64_tr_b16 v[36:37], v17 offset:12288
    s_add_u32 m0, s34, 69632
    s_nop 0
    buffer_load_dwordx4 v8, s[16:19], s53 offen offset:0  lds
    v_mfma_f32_16x16x32_bf16 v[160:163], v[80:83], v[68:71], 0
    ds_read_b64_tr_b16 v[38:39], v17 offset:12800
    v_mfma_f32_16x16x32_bf16 v[168:171], v[80:83], v[72:75], 0
    ds_read_b64_tr_b16 v[40:41], v18 offset:12288
    v_mfma_f32_16x16x32_bf16 v[164:167], v[76:79], v[72:75], 0
    ds_read_b64_tr_b16 v[42:43], v18 offset:12800
    buffer_load_dwordx4 v9, s[16:19], s53 offen offset:1024  lds
    v_mfma_f32_16x16x32_bf16 v[192:195], v[72:75], v[84:87], 0
    ds_read_b64_tr_b16 v[44:45], v17 offset:13312
    v_mfma_f32_16x16x32_bf16 v[200:203], v[72:75], v[88:91], 0
    ds_read_b64_tr_b16 v[46:47], v17 offset:13824
    buffer_load_dwordx4 v10, s[16:19], s53 offen offset:2048  lds
    v_mfma_f32_16x16x32_bf16 v[224:227], v[72:75], v[92:95], 0
    ds_read_b64_tr_b16 v[48:49], v18 offset:13312
    v_mfma_f32_16x16x32_bf16 v[232:235], v[72:75], v[96:99], 0
    ds_read_b64_tr_b16 v[50:51], v18 offset:13824
    buffer_load_dwordx4 v11, s[16:19], s53 offen offset:3072  lds
    s_add_u32 s36, s36, 128
    s_cmp_ge_u32 s36, 2048
    s_cselect_b32 s36, 0x40000000, s36
    s_add_u32 s53, s36, 0x10000
    v_mfma_f32_16x16x32_bf16 v[228:231], v[68:71], v[96:99], 0
    ds_read_b64_tr_b16 v[52:53], v17 offset:14336
    v_mfma_f32_16x16x32_bf16 v[220:223], v[68:71], v[92:95], 0
    ds_read_b64_tr_b16 v[54:55], v17 offset:14848
    v_mfma_f32_16x16x32_bf16 v[196:199], v[68:71], v[88:91], 0
    ds_read_b64_tr_b16 v[56:57], v18 offset:14336
    s_add_u32 m0, s35, 49152
    s_nop 0
    buffer_load_dwordx4 v12, s[20:23], s37 offen offset:0  lds
    v_mfma_f32_16x16x32_bf16 v[188:191], v[68:71], v[84:87], 0
    ds_read_b64_tr_b16 v[58:59], v18 offset:14848
    v_mfma_f32_16x16x32_bf16 v[176:179], v[64:67], v[84:87], 0
    buffer_load_dwordx4 v13, s[20:23], s37 offen offset:1024  lds
    v_mfma_f32_16x16x32_bf16 v[184:187], v[64:67], v[88:91], 0
    v_mfma_f32_16x16x32_bf16 v[208:211], v[64:67], v[92:95], 0
    buffer_load_dwordx4 v14, s[20:23], s37 offen offset:2048  lds
    s_add_u32 s37, s37, 196608
    v_add_u32 v15, 32768, v15
    v_add_u32 v16, 32768, v16
    v_mfma_f32_16x16x32_bf16 v[216:219], v[64:67], v[96:99], 0
    v_add_u32 v17, 24576, v17
    v_add_u32 v18, 24576, v18
    v_mfma_f32_16x16x32_bf16 v[212:215], v[60:63], v[96:99], 0
    v_mfma_f32_16x16x32_bf16 v[204:207], v[60:63], v[92:95], 0
    v_mfma_f32_16x16x32_bf16 v[180:183], v[60:63], v[88:91], 0
    v_mfma_f32_16x16x32_bf16 v[172:175], v[60:63], v[84:87], 0
.p2align 6
L_k1_loopA0:
    s_waitcnt lgkmcnt(0)
    s_waitcnt vmcnt(11)
    s_barrier
    v_mfma_f32_16x16x32_bf16 v[140:143], v[36:39], v[20:23], v[140:143]
    ds_read_b128 v[60:63], v15 offset:0
    s_add_u32 m0, s35, s54
    s_nop 0
    buffer_load_dwordx4 v12, s[20:23], s37 offen offset:0  lds
    v_mfma_f32_16x16x32_bf16 v[144:147], v[40:43], v[20:23], v[144:147]
    ds_read_b128 v[64:67], v15 offset:2048
    v_mfma_f32_16x16x32_bf16 v[152:155], v[40:43], v[24:27], v[152:155]
    ds_read_b128 v[68:71], v15 offset:4096
    v_mfma_f32_16x16x32_bf16 v[148:151], v[36:39], v[24:27], v[148:151]
    ds_read_b128 v[72:75], v15 offset:6144
    buffer_load_dwordx4 v13, s[20:23], s37 offen offset:1024  lds
    v_mfma_f32_16x16x32_bf16 v[156:159], v[36:39], v[28:31], v[156:159]
    ds_read_b64_tr_b16 v[76:77], v17 offset:0
    v_mfma_f32_16x16x32_bf16 v[160:163], v[40:43], v[28:31], v[160:163]
    ds_read_b64_tr_b16 v[78:79], v17 offset:512
    v_mfma_f32_16x16x32_bf16 v[168:171], v[40:43], v[32:35], v[168:171]
    ds_read_b64_tr_b16 v[80:81], v18 offset:0
    buffer_load_dwordx4 v14, s[20:23], s37 offen offset:2048  lds
    s_add_u32 s37, s37, 196608
    s_add_u32 s54, s54, 12288
    s_cmp_eq_u32 s54, 61440
    s_cselect_b32 s54, 0, s54
    v_mfma_f32_16x16x32_bf16 v[164:167], v[36:39], v[32:35], v[164:167]
    ds_read_b64_tr_b16 v[82:83], v18 offset:512
    v_mfma_f32_16x16x32_bf16 v[192:195], v[32:35], v[44:47], v[192:195]
    ds_read_b64_tr_b16 v[84:85], v17 offset:1024
    v_mfma_f32_16x16x32_bf16 v[200:203], v[32:35], v[48:51], v[200:203]
    ds_read_b64_tr_b16 v[86:87], v17 offset:1536
    s_add_u32 m0, s34, s48
    s_nop 0
    buffer_load_dwordx4 v8, s[16:19], s36 offen offset:0  lds
    v_mfma_f32_16x16x32_bf16 v[224:227], v[32:35], v[52:55], v[224:227]
    ds_read_b64_tr_b16 v[88:89], v18 offset:1024
    v_mfma_f32_16x16x32_bf16 v[232:235], v[32:35], v[56:59], v[232:235]
    ds_read_b64_tr_b16 v[90:91], v18 offset:1536
    v_mfma_f32_16x16x32_bf16 v[228:231], v[28:31], v[56:59], v[228:231]
    ds_read_b64_tr_b16 v[92:93], v17 offset:2048
    buffer_load_dwordx4 v9, s[16:19], s36 offen offset:1024  lds
    v_mfma_f32_16x16x32_bf16 v[220:223], v[28:31], v[52:55], v[220:223]
    ds_read_b64_tr_b16 v[94:95], v17 offset:2560
    v_mfma_f32_16x16x32_bf16 v[196:199], v[28:31], v[48:51], v[196:199]
    ds_read_b64_tr_b16 v[96:97], v18 offset:2048
    v_mfma_f32_16x16x32_bf16 v[188:191], v[28:31], v[44:47], v[188:191]
    ds_read_b64_tr_b16 v[98:99], v18 offset:2560
    buffer_load_dwordx4 v10, s[16:19], s36 offen offset:2048  lds
    v_mfma_f32_16x16x32_bf16 v[176:179], v[24:27], v[44:47], v[176:179]
    v_mfma_f32_16x16x32_bf16 v[184:187], v[24:27], v[48:51], v[184:187]
    v_mfma_f32_16x16x32_bf16 v[208:211], v[24:27], v[52:55], v[208:211]
    buffer_load_dwordx4 v11, s[16:19], s36 offen offset:3072  lds
    s_cmp_eq_u32 s50, 49152
    s_cselect_b32 s51, s44, s45
    v_mfma_f32_16x16x32_bf16 v[216:219], v[24:27], v[56:59], v[216:219]
    s_add_u32 s50, s50, s51
    v_add_u32 v17, s51, v17
    v_mfma_f32_16x16x32_bf16 v[212:215], v[20:23], v[56:59], v[212:215]
    v_add_u32 v18, s51, v18
    v_mfma_f32_16x16x32_bf16 v[204:207], v[20:23], v[52:55], v[204:207]
    v_mfma_f32_16x16x32_bf16 v[180:183], v[20:23], v[48:51], v[180:183]
    v_mfma_f32_16x16x32_bf16 v[172:175], v[20:23], v[44:47], v[172:175]
    s_waitcnt lgkmcnt(0)
    v_mfma_f32_16x16x32_bf16 v[140:143], v[76:79], v[60:63], v[140:143]
    ds_read_b128 v[20:23], v16 offset:0
    s_add_u32 m0, s34, s48
    s_add_u32 m0, m0, 4096
    s_nop 0
    buffer_load_dwordx4 v8, s[16:19], s53 offen offset:0  lds
    v_mfma_f32_16x16x32_bf16 v[144:147], v[80:83], v[60:63], v[144:147]
    ds_read_b128 v[24:27], v16 offset:2048
    v_mfma_f32_16x16x32_bf16 v[152:155], v[80:83], v[64:67], v[152:155]
    ds_read_b128 v[28:31], v16 offset:4096
    buffer_load_dwordx4 v9, s[16:19], s53 offen offset:1024  lds
    v_mfma_f32_16x16x32_bf16 v[148:151], v[76:79], v[64:67], v[148:151]
    ds_read_b128 v[32:35], v16 offset:6144
    v_mfma_f32_16x16x32_bf16 v[156:159], v[76:79], v[68:71], v[156:159]
    ds_read_b64_tr_b16 v[36:37], v17 offset:0
    v_mfma_f32_16x16x32_bf16 v[160:163], v[80:83], v[68:71], v[160:163]
    ds_read_b64_tr_b16 v[38:39], v17 offset:512
    buffer_load_dwordx4 v10, s[16:19], s53 offen offset:2048  lds
    v_mfma_f32_16x16x32_bf16 v[168:171], v[80:83], v[72:75], v[168:171]
    ds_read_b64_tr_b16 v[40:41], v18 offset:0
    v_mfma_f32_16x16x32_bf16 v[164:167], v[76:79], v[72:75], v[164:167]
    ds_read_b64_tr_b16 v[42:43], v18 offset:512
    v_mfma_f32_16x16x32_bf16 v[192:195], v[72:75], v[84:87], v[192:195]
    ds_read_b64_tr_b16 v[44:45], v17 offset:1024
    buffer_load_dwordx4 v11, s[16:19], s53 offen offset:3072  lds
    s_add_u32 s36, s36, 128
    s_cmp_ge_u32 s36, 2048
    s_cselect_b32 s36, 0x40000000, s36
    s_add_u32 s53, s36, 0x10000
    v_mfma_f32_16x16x32_bf16 v[200:203], v[72:75], v[88:91], v[200:203]
    ds_read_b64_tr_b16 v[46:47], v17 offset:1536
    v_mfma_f32_16x16x32_bf16 v[224:227], v[72:75], v[92:95], v[224:227]
    ds_read_b64_tr_b16 v[48:49], v18 offset:1024
    s_add_u32 m0, s35, s54
    s_nop 0
    buffer_load_dwordx4 v12, s[20:23], s37 offen offset:0  lds
    v_mfma_f32_16x16x32_bf16 v[232:235], v[72:75], v[96:99], v[232:235]
    ds_read_b64_tr_b16 v[50:51], v18 offset:1536
    v_mfma_f32_16x16x32_bf16 v[228:231], v[68:71], v[96:99], v[228:231]
    ds_read_b64_tr_b16 v[52:53], v17 offset:2048
    v_mfma_f32_16x16x32_bf16 v[220:223], v[68:71], v[92:95], v[220:223]
    ds_read_b64_tr_b16 v[54:55], v17 offset:2560
    buffer_load_dwordx4 v13, s[20:23], s37 offen offset:1024  lds
    v_mfma_f32_16x16x32_bf16 v[196:199], v[68:71], v[88:91], v[196:199]
    ds_read_b64_tr_b16 v[56:57], v18 offset:2048
    v_mfma_f32_16x16x32_bf16 v[188:191], v[68:71], v[84:87], v[188:191]
    ds_read_b64_tr_b16 v[58:59], v18 offset:2560
    v_mfma_f32_16x16x32_bf16 v[176:179], v[64:67], v[84:87], v[176:179]
    buffer_load_dwordx4 v14, s[20:23], s37 offen offset:2048  lds
    s_add_u32 s37, s37, 196608
    s_add_u32 s54, s54, 12288
    s_cmp_eq_u32 s54, 61440
    s_cselect_b32 s54, 0, s54
    s_mov_b32 s48, s49
    s_add_u32 s49, s49, 32768
    v_mfma_f32_16x16x32_bf16 v[184:187], v[64:67], v[88:91], v[184:187]
    s_cmp_eq_u32 s49, 98304
    s_cselect_b32 s49, 0, s49
    v_mfma_f32_16x16x32_bf16 v[208:211], v[64:67], v[92:95], v[208:211]
    s_sub_u32 s51, s49, s48
    v_add_u32 v15, s51, v15
    v_mfma_f32_16x16x32_bf16 v[216:219], v[64:67], v[96:99], v[216:219]
    v_add_u32 v16, s51, v16
    s_cmp_eq_u32 s50, 49152
    v_mfma_f32_16x16x32_bf16 v[212:215], v[60:63], v[96:99], v[212:215]
    s_cselect_b32 s51, s44, s45
    s_add_u32 s50, s50, s51
    v_mfma_f32_16x16x32_bf16 v[204:207], v[60:63], v[92:95], v[204:207]
    v_add_u32 v17, s51, v17
    v_add_u32 v18, s51, v18
    v_mfma_f32_16x16x32_bf16 v[180:183], v[60:63], v[88:91], v[180:183]
    s_sub_u32 s52, s52, 1
    s_cmp_lg_u32 s52, 0
    v_mfma_f32_16x16x32_bf16 v[172:175], v[60:63], v[84:87], v[172:175]
    s_cbranch_scc1 L_k1_loopA0
    s_branch L_k1_tailA
L_k1_A1:
    s_barrier
    ds_read_b128 v[60:63], v15 offset:0
    ds_read_b128 v[64:67], v15 offset:2048
    ds_read_b128 v[68:71], v15 offset:4096
    ds_read_b128 v[72:75], v15 offset:6144
    ds_read_b64_tr_b16 v[76:77], v17 offset:0
    ds_read_b64_tr_b16 v[78:79], v17 offset:512
    ds_read_b64_tr_b16 v[80:81], v18 offset:0
    ds_read_b64_tr_b16 v[82:83], v18 offset:512
    ds_read_b64_tr_b16 v[84:85], v17 offset:1024
    ds_read_b64_tr_b16 v[86:87], v17 offset:1536
    ds_read_b64_tr_b16 v[88:89], v18 offset:1024
    ds_read_b64_tr_b16 v[90:91], v18 offset:1536
    ds_read_b64_tr_b16 v[92:93], v17 offset:2048
    ds_read_b64_tr_b16 v[94:95], v17 offset:2560
    ds_read_b64_tr_b16 v[96:97], v18 offset:2048
    ds_read_b64_tr_b16 v[98:99], v18 offset:2560
    s_waitcnt lgkmcnt(0)
    v_mfma_f32_16x16x32_bf16 v[140:143], v[76:79], v[60:63], 0
    ds_read_b128 v[20:23], v16 offset:0
    v_mfma_f32_16x16x32_bf16 v[144:147], v[80:83], v[60:63], 0
    ds_read_b128 v[24:27], v16 offset:2048
    v_mfma_f32_16x16x32_bf16 v[152:155], v[80:83], v[64:67], 0
    ds_read_b128 v[28:31], v16 offset:4096
    v_mfma_f32_16x16x32_bf16 v[148:151], v[76:79], v[64:67], 0
    ds_read_b128 v[32:35], v16 offset:6144
    v_mfma_f32_16x16x32_bf16 v[156:159], v[76:79], v[68:71], 0
    ds_read_b64_tr_b16 v[36:37], v17 offset:12288
    v_mfma_f32_16x16x32_bf16 v[160:163], v[80:83], v[68:71], 0
    ds_read_b64_tr_b16 v[38:39], v17 offset:12800
    v_mfma_f32_16x16x32_bf16 v[168:171], v[80:83], v[72:75], 0
    ds_read_b64_tr_b16 v[40:41], v18 offset:12288
    v_mfma_f32_16x16x32_bf16 v[164:167], v[76:79], v[72:75], 0
    ds_read_b64_tr_b16 v[42:43], v18 offset:12800
    v_mfma_f32_16x16x32_bf16 v[192:195], v[72:75], v[84:87], 0
    ds_read_b64_tr_b16 v[44:45], v17 offset:13312
    v_mfma_f32_16x16x32_bf16 v[200:203], v[72:75], v[88:91], 0
    ds_read_b64_tr_b16 v[46:47], v17 offset:13824
    v_mfma_f32_16x16x32_bf16 v[224:227], v[72:75], v[92:95], 0
    ds_read_b64_tr_b16 v[48:49], v18 offset:13312
    v_mfma_f32_16x16x32_bf16 v[232:235], v[72:75], v[96:99], 0
    ds_read_b64_tr_b16 v[50:51], v18 offset:13824
    v_mfma_f32_16x16x32_bf16 v[228:231], v[68:71], v[96:99], 0
    ds_read_b64_tr_b16 v[52:53], v17 offset:14336
    v_mfma_f32_16x16x32_bf16 v[220:223], v[68:71], v[92:95], 0
    ds_read_b64_tr_b16 v[54:55], v17 offset:14848
    v_mfma_f32_16x16x32_bf16 v[196:199], v[68:71], v[88:91], 0
    ds_read_b64_tr_b16 v[56:57], v18 offset:14336
    v_mfma_f32_16x16x32_bf16 v[188:191], v[68:71], v[84:87], 0
    ds_read_b64_tr_b16 v[58:59], v18 offset:14848
    v_add_u32 v15, 32768, v15
    v_add_u32 v16, 32768, v16
    v_mfma_f32_16x16x32_bf16 v[176:179], v[64:67], v[84:87], 0
    v_add_u32 v17, 24576, v17
    v_add_u32 v18, 24576, v18
    v_mfma_f32_16x16x32_bf16 v[184:187], v[64:67], v[88:91], 0
    v_mfma_f32_16x16x32_bf16 v[208:211], v[64:67], v[92:95], 0
    v_mfma_f32_16x16x32_bf16 v[216:219], v[64:67], v[96:99], 0
    v_mfma_f32_16x16x32_bf16 v[212:215], v[60:63], v[96:99], 0
    v_mfma_f32_16x16x32_bf16 v[204:207], v[60:63], v[92:95], 0
    v_mfma_f32_16x16x32_bf16 v[180:183], v[60:63], v[88:91], 0
    v_mfma_f32_16x16x32_bf16 v[172:175], v[60:63], v[84:87], 0
    s_mov_b64 exec, 3
    buffer_load_dword v19, v7, s[56:59], 0 offen
    s_mov_b64 exec, -1
    s_lshl_b32 s40, s2, 3
    s_add_u32 s40, s40, s31
    s_cmp_eq_u32 s40, 4
    s_cbranch_scc0 L_p1_nopub
    s_memrealtime s[42:43]
    s_waitcnt vmcnt(1) lgkmcnt(0)
    s_and_b32 s42, s42, 0x3fffffff
    s_add_u32 s42, s42, 1
    v_add_u32 v236, s42, v236
    v_max_u32 v236, 1, v236
    v_mov_b32 v7, 19005440
    v_mov_b32 v124, 0
    s_mov_b64 exec, 1
    buffer_store_dword v236, v7, s[24:27], 0 offen sc1
    buffer_store_dword v236, v124, s[12:15], 0 offen sc1
    s_mov_b64 exec, -1
L_p1_nopub:
.p2align 6
L_k1_loopA1:
    s_waitcnt lgkmcnt(0)
    s_barrier
    v_mfma_f32_16x16x32_bf16 v[140:143], v[36:39], v[20:23], v[140:143]
    ds_read_b128 v[60:63], v15 offset:0
    v_mfma_f32_16x16x32_bf16 v[144:147], v[40:43], v[20:23], v[144:147]
    ds_read_b128 v[64:67], v15 offset:2048
    v_mfma_f32_16x16x32_bf16 v[152:155], v[40:43], v[24:27], v[152:155]
    ds_read_b128 v[68:71], v15 offset:4096
    v_mfma_f32_16x16x32_bf16 v[148:151], v[36:39], v[24:27], v[148:151]
    ds_read_b128 v[72:75], v15 offset:6144
    v_mfma_f32_16x16x32_bf16 v[156:159], v[36:39], v[28:31], v[156:159]
    ds_read_b64_tr_b16 v[76:77], v17 offset:0
    v_mfma_f32_16x16x32_bf16 v[160:163], v[40:43], v[28:31], v[160:163]
    ds_read_b64_tr_b16 v[78:79], v17 offset:512
    v_mfma_f32_16x16x32_bf16 v[168:171], v[40:43], v[32:35], v[168:171]
    ds_read_b64_tr_b16 v[80:81], v18 offset:0
    v_mfma_f32_16x16x32_bf16 v[164:167], v[36:39], v[32:35], v[164:167]
    ds_read_b64_tr_b16 v[82:83], v18 offset:512
    v_mfma_f32_16x16x32_bf16 v[192:195], v[32:35], v[44:47], v[192:195]
    ds_read_b64_tr_b16 v[84:85], v17 offset:1024
    v_mfma_f32_16x16x32_bf16 v[200:203], v[32:35], v[48:51], v[200:203]
    ds_read_b64_tr_b16 v[86:87], v17 offset:1536
    v_mfma_f32_16x16x32_bf16 v[224:227], v[32:35], v[52:55], v[224:227]
    ds_read_b64_tr_b16 v[88:89], v18 offset:1024
    v_mfma_f32_16x16x32_bf16 v[232:235], v[32:35], v[56:59], v[232:235]
    ds_read_b64_tr_b16 v[90:91], v18 offset:1536
    v_mfma_f32_16x16x32_bf16 v[228:231], v[28:31], v[56:59], v[228:231]
    ds_read_b64_tr_b16 v[92:93], v17 offset:2048
    v_mfma_f32_16x16x32_bf16 v[220:223], v[28:31], v[52:55], v[220:223]
    ds_read_b64_tr_b16 v[94:95], v17 offset:2560
    v_mfma_f32_16x16x32_bf16 v[196:199], v[28:31], v[48:51], v[196:199]
    ds_read_b64_tr_b16 v[96:97], v18 offset:2048
    v_mfma_f32_16x16x32_bf16 v[188:191], v[28:31], v[44:47], v[188:191]
    ds_read_b64_tr_b16 v[98:99], v18 offset:2560
    s_cmp_eq_u32 s50, 49152
    s_cselect_b32 s51, s44, s45
    v_mfma_f32_16x16x32_bf16 v[176:179], v[24:27], v[44:47], v[176:179]
    s_add_u32 s50, s50, s51
    v_add_u32 v17, s51, v17
    v_mfma_f32_16x16x32_bf16 v[184:187], v[24:27], v[48:51], v[184:187]
    v_add_u32 v18, s51, v18
    v_mfma_f32_16x16x32_bf16 v[208:211], v[24:27], v[52:55], v[208:211]
    v_mfma_f32_16x16x32_bf16 v[216:219], v[24:27], v[56:59], v[216:219]
    v_mfma_f32_16x16x32_bf16 v[212:215], v[20:23], v[56:59], v[212:215]
    v_mfma_f32_16x16x32_bf16 v[204:207], v[20:23], v[52:55], v[204:207]
    v_mfma_f32_16x16x32_bf16 v[180:183], v[20:23], v[48:51], v[180:183]
    v_mfma_f32_16x16x32_bf16 v[172:175], v[20:23], v[44:47], v[172:175]
    s_waitcnt lgkmcnt(0)
    v_mfma_f32_16x16x32_bf16 v[140:143], v[76:79], v[60:63], v[140:143]
    ds_read_b128 v[20:23], v16 offset:0
    v_mfma_f32_16x16x32_bf16 v[144:147], v[80:83], v[60:63], v[144:147]
    ds_read_b128 v[24:27], v16 offset:2048
    v_mfma_f32_16x16x32_bf16 v[152:155], v[80:83], v[64:67], v[152:155]
    ds_read_b128 v[28:31], v16 offset:4096
    v_mfma_f32_16x16x32_bf16 v[148:151], v[76:79], v[64:67], v[148:151]
    ds_read_b128 v[32:35], v16 offset:6144
    v_mfma_f32_16x16x32_bf16 v[156:159], v[76:79], v[68:71], v[156:159]
    ds_read_b64_tr_b16 v[36:37], v17 offset:0
    v_mfma_f32_16x16x32_bf16 v[160:163], v[80:83], v[68:71], v[160:163]
    ds_read_b64_tr_b16 v[38:39], v17 offset:512
    v_mfma_f32_16x16x32_bf16 v[168:171], v[80:83], v[72:75], v[168:171]
    ds_read_b64_tr_b16 v[40:41], v18 offset:0
    v_mfma_f32_16x16x32_bf16 v[164:167], v[76:79], v[72:75], v[164:167]
    ds_read_b64_tr_b16 v[42:43], v18 offset:512
    v_mfma_f32_16x16x32_bf16 v[192:195], v[72:75], v[84:87], v[192:195]
    ds_read_b64_tr_b16 v[44:45], v17 offset:1024
    v_mfma_f32_16x16x32_bf16 v[200:203], v[72:75], v[88:91], v[200:203]
    ds_read_b64_tr_b16 v[46:47], v17 offset:1536
    v_mfma_f32_16x16x32_bf16 v[224:227], v[72:75], v[92:95], v[224:227]
    ds_read_b64_tr_b16 v[48:49], v18 offset:1024
    v_mfma_f32_16x16x32_bf16 v[232:235], v[72:75], v[96:99], v[232:235]
    ds_read_b64_tr_b16 v[50:51], v18 offset:1536
    v_mfma_f32_16x16x32_bf16 v[228:231], v[68:71], v[96:99], v[228:231]
    ds_read_b64_tr_b16 v[52:53], v17 offset:2048
    v_mfma_f32_16x16x32_bf16 v[220:223], v[68:71], v[92:95], v[220:223]
    ds_read_b64_tr_b16 v[54:55], v17 offset:2560
    v_mfma_f32_16x16x32_bf16 v[196:199], v[68:71], v[88:91], v[196:199]
    ds_read_b64_tr_b16 v[56:57], v18 offset:2048
    v_mfma_f32_16x16x32_bf16 v[188:191], v[68:71], v[84:87], v[188:191]
    ds_read_b64_tr_b16 v[58:59], v18 offset:2560
    s_mov_b32 s48, s49
    s_add_u32 s49, s49, 32768
    v_mfma_f32_16x16x32_bf16 v[176:179], v[64:67], v[84:87], v[176:179]
    s_cmp_eq_u32 s49, 98304
    s_cselect_b32 s49, 0, s49
    v_mfma_f32_16x16x32_bf16 v[184:187], v[64:67], v[88:91], v[184:187]
    s_sub_u32 s51, s49, s48
    v_add_u32 v15, s51, v15
    v_mfma_f32_16x16x32_bf16 v[208:211], v[64:67], v[92:95], v[208:211]
    v_add_u32 v16, s51, v16
    s_cmp_eq_u32 s50, 49152
    v_mfma_f32_16x16x32_bf16 v[216:219], v[64:67], v[96:99], v[216:219]
    s_cselect_b32 s51, s44, s45
    s_add_u32 s50, s50, s51
    v_mfma_f32_16x16x32_bf16 v[212:215], v[60:63], v[96:99], v[212:215]
    v_add_u32 v17, s51, v17
    v_add_u32 v18, s51, v18
    v_mfma_f32_16x16x32_bf16 v[204:207], v[60:63], v[92:95], v[204:207]
    s_sub_u32 s52, s52, 1
    s_cmp_lg_u32 s52, 0
    v_mfma_f32_16x16x32_bf16 v[180:183], v[60:63], v[88:91], v[180:183]
    v_mfma_f32_16x16x32_bf16 v[172:175], v[60:63], v[84:87], v[172:175]
    s_cbranch_scc1 L_k1_loopA1
L_k1_tailA:
    s_waitcnt lgkmcnt(0)
    s_waitcnt vmcnt(0)
    s_barrier
    s_cmp_lg_u32 s31, 0
    s_cbranch_scc1 L_p1_notA
    v_mov_b32 v19, 0
    buffer_load_dword v236, v19, s[12:15], 0 offen sc1
L_p1_notA:
    s_setprio 2
    ds_read_b128 v[60:63], v15 offset:0
    ds_read_b128 v[64:67], v15 offset:2048
    ds_read_b128 v[68:71], v15 offset:4096
    ds_read_b128 v[72:75], v15 offset:6144
    ds_read_b64_tr_b16 v[92:93], v17 offset:1024
    ds_read_b64_tr_b16 v[94:95], v17 offset:1536
    ds_read_b64_tr_b16 v[96:97], v18 offset:1024
    ds_read_b64_tr_b16 v[98:99], v18 offset:1536
    v_mfma_f32_16x16x32_bf16 v[172:175], v[20:23], v[44:47], v[172:175]
    ds_read_b128 v[76:79], v16 offset:0
    s_lshl_b32 s40, s30, 1
    s_add_u32 s40, s40, s33
    s_lshl_b32 s41, s29, 3
    v_mfma_f32_16x16x32_bf16 v[180:183], v[20:23], v[48:51], v[180:183]
    ds_read_b128 v[80:83], v16 offset:2048
    s_lshl_b32 s42, s32, 1
    s_add_u32 s41, s41, s42
    v_mfma_f32_16x16x32_bf16 v[176:179], v[24:27], v[44:47], v[176:179]
    ds_read_b128 v[84:87], v16 offset:4096
    s_lshl_b32 s42, s40, 17
    s_lshl_b32 s41, s41, 11
    v_mfma_f32_16x16x32_bf16 v[184:187], v[24:27], v[48:51], v[184:187]
    ds_read_b128 v[88:91], v16 offset:6144
    s_add_u32 s42, s42, s41
    s_add_u32 s100, s42, 12582912
    v_mfma_f32_16x16x32_bf16 v[188:191], v[28:31], v[44:47], v[188:191]
    ds_read_b64_tr_b16 v[100:101], v17 offset:13312
    s_add_u32 s40, s30, 1
    s_and_b32 s40, s40, s55
    s_and_b32 s36, s30, s47
    v_mfma_f32_16x16x32_bf16 v[196:199], v[28:31], v[48:51], v[196:199]
    ds_read_b64_tr_b16 v[102:103], v17 offset:13824
    s_or_b32 s40, s40, s36
    s_lshl_b32 s40, s40, 1
    v_mfma_f32_16x16x32_bf16 v[192:195], v[32:35], v[44:47], v[192:195]
    ds_read_b64_tr_b16 v[104:105], v18 offset:13312
    s_add_u32 s40, s40, s33
    s_mov_b32 s44, 0x3fb8aa3b
    v_mfma_f32_16x16x32_bf16 v[200:203], v[32:35], v[48:51], v[200:203]
    ds_read_b64_tr_b16 v[106:107], v18 offset:13824
    s_waitcnt lgkmcnt(8)
    s_mov_b32 s45, 0x3fb8aa3b
    s_mov_b32 s46, 0x358637bd
    v_mfma_f32_16x16x32_bf16 v[172:175], v[60:63], v[92:95], v[172:175]
    s_lshl_b32 s43, s31, 12
    s_add_u32 s43, s43, 94208
    v_lshlrev_b32 v7, 4, v1
    v_mfma_f32_16x16x32_bf16 v[180:183], v[60:63], v[96:99], v[180:183]
    v_add_u32 v4, s43, v7
    s_lshl_b32 s43, s31, 7
    v_mfma_f32_16x16x32_bf16 v[176:179], v[64:67], v[92:95], v[176:179]
    s_add_u32 s43, s43, 94208
    v_lshlrev_b32 v5, 2, v2
    v_mfma_f32_16x16x32_bf16 v[184:187], v[64:67], v[96:99], v[184:187]
    v_add_u32 v5, s43, v5
    s_lshl_b32 s43, s33, 14
    v_mfma_f32_16x16x32_bf16 v[188:191], v[68:71], v[92:95], v[188:191]
    s_lshl_b32 s41, s32, 10
    s_add_u32 s43, s43, s41
    s_add_u32 s43, s43, 94208
    v_mfma_f32_16x16x32_bf16 v[196:199], v[68:71], v[96:99], v[196:199]
    v_add_u32 v8, s43, v7
    v_and_b32 v11, 31, v1
    v_mfma_f32_16x16x32_bf16 v[192:195], v[72:75], v[92:95], v[192:195]
    v_lshlrev_b32 v11, 2, v11
    s_lshl_b32 s43, s33, 9
    v_mfma_f32_16x16x32_bf16 v[200:203], v[72:75], v[96:99], v[200:203]
    s_waitcnt lgkmcnt(0)
    s_add_u32 s43, s43, 94208
    v_add_u32 v9, s43, v11
    v_mfma_f32_16x16x32_bf16 v[172:175], v[76:79], v[100:103], v[172:175]
    ds_read_b64_tr_b16 v[108:109], v17 offset:2048
    s_lshl_b32 s42, s40, 15
    s_lshr_b32 s43, s32, 1
    s_lshl_b32 s43, s43, 13
    v_mfma_f32_16x16x32_bf16 v[180:183], v[76:79], v[104:107], v[180:183]
    ds_read_b64_tr_b16 v[110:111], v17 offset:2560
    s_add_u32 s42, s42, s43
    s_and_b32 s43, s32, 1
    v_mfma_f32_16x16x32_bf16 v[176:179], v[80:83], v[100:103], v[176:179]
    ds_read_b64_tr_b16 v[112:113], v18 offset:2048
    s_lshl_b32 s43, s43, 8
    s_add_u32 s42, s42, s43
    v_mfma_f32_16x16x32_bf16 v[184:187], v[80:83], v[104:107], v[184:187]
    ds_read_b64_tr_b16 v[114:115], v18 offset:2560
    s_lshl_b32 s43, s29, 10
    s_add_u32 s42, s42, s43
    v_mfma_f32_16x16x32_bf16 v[188:191], v[84:87], v[100:103], v[188:191]
    ds_read_b64_tr_b16 v[116:117], v17 offset:14336
    s_add_u32 s42, s42, 16777216
    v_lshlrev_b32 v10, 4, v2
    v_and_b32 v7, 1, v3
    v_mfma_f32_16x16x32_bf16 v[196:199], v[84:87], v[104:107], v[196:199]
    ds_read_b64_tr_b16 v[118:119], v17 offset:14848
    v_lshl_add_u32 v10, v7, 9, v10
    v_lshrrev_b32 v7, 1, v3
    v_mfma_f32_16x16x32_bf16 v[192:195], v[88:91], v[100:103], v[192:195]
    ds_read_b64_tr_b16 v[120:121], v18 offset:14336
    v_lshl_add_u32 v10, v7, 14, v10
    s_lshl_b32 s40, s40, 13
    v_mfma_f32_16x16x32_bf16 v[200:203], v[88:91], v[104:107], v[200:203]
    ds_read_b64_tr_b16 v[122:123], v18 offset:14848
    s_add_u32 s40, s40, s43
    s_add_u32 s40, s40, 17825792
    s_setprio 1
    v_mfma_f32_16x16x32_bf16 v[204:207], v[20:23], v[52:55], v[204:207]
    v_mfma_f32_16x16x32_bf16 v[212:215], v[20:23], v[56:59], v[212:215]
    v_mfma_f32_16x16x32_bf16 v[208:211], v[24:27], v[52:55], v[208:211]
    v_mfma_f32_16x16x32_bf16 v[216:219], v[24:27], v[56:59], v[216:219]
    v_mfma_f32_16x16x32_bf16 v[220:223], v[28:31], v[52:55], v[220:223]
    v_mul_f32 v124, s44, v172
    v_mul_f32 v125, s44, v173
    v_mul_f32 v126, s44, v174
    v_mul_f32 v127, s44, v175
    v_mul_f32 v128, s44, v176
    v_mul_f32 v129, s44, v177
    v_mul_f32 v130, s44, v178
    v_mul_f32 v131, s44, v179
    v_mfma_f32_16x16x32_bf16 v[228:231], v[28:31], v[56:59], v[228:231]
    v_mul_f32 v132, s44, v180
    v_mul_f32 v133, s44, v181
    v_mul_f32 v134, s44, v182
    v_mul_f32 v135, s44, v183
    v_mul_f32 v136, s44, v184
    v_mul_f32 v137, s44, v185
    v_mul_f32 v138, s44, v186
    v_mfma_f32_16x16x32_bf16 v[224:227], v[32:35], v[52:55], v[224:227]
    v_mul_f32 v139, s44, v187
    v_exp_f32 v124, v124 clamp
    v_max_f32 v172, s46, v172
    v_exp_f32 v125, v125 clamp
    v_max_f32 v173, s46, v173
    v_exp_f32 v126, v126 clamp
    v_max_f32 v174, s46, v174
    v_mfma_f32_16x16x32_bf16 v[232:235], v[32:35], v[56:59], v[232:235]
    s_waitcnt lgkmcnt(0)
    v_exp_f32 v127, v127 clamp
    v_max_f32 v175, s46, v175
    v_exp_f32 v128, v128 clamp
    v_max_f32 v176, s46, v176
    v_exp_f32 v129, v129 clamp
    v_max_f32 v177, s46, v177
    v_exp_f32 v130, v130 clamp
    v_mfma_f32_16x16x32_bf16 v[204:207], v[60:63], v[108:111], v[204:207]
    ds_read_b64_tr_b16 v[92:93], v17 offset:0
    v_max_f32 v178, s46, v178
    v_exp_f32 v131, v131 clamp
    v_max_f32 v179, s46, v179
    v_exp_f32 v132, v132 clamp
    v_max_f32 v180, s46, v180
    v_exp_f32 v133, v133 clamp
    v_max_f32 v181, s46, v181
    v_mfma_f32_16x16x32_bf16 v[212:215], v[60:63], v[112:115], v[212:215]
    ds_read_b64_tr_b16 v[94:95], v17 offset:512
    v_exp_f32 v134, v134 clamp
    v_max_f32 v182, s46, v182
    v_exp_f32 v135, v135 clamp
    v_max_f32 v183, s46, v183
    v_exp_f32 v136, v136 clamp
    v_max_f32 v184, s46, v184
    v_exp_f32 v137, v137 clamp
    v_max_f32 v185, s46, v185
    v_mfma_f32_16x16x32_bf16 v[208:211], v[64:67], v[108:111], v[208:211]
    ds_read_b64_tr_b16 v[96:97], v18 offset:0
    v_exp_f32 v138, v138 clamp
    v_max_f32 v186, s46, v186
    v_exp_f32 v139, v139 clamp
    v_max_f32 v187, s46, v187
    v_add_f32 v172, v172, v124
    v_add_f32 v173, v173, v125
    v_add_f32 v174, v174, v126
    v_mfma_f32_16x16x32_bf16 v[216:219], v[64:67], v[112:115], v[216:219]
    ds_read_b64_tr_b16 v[98:99], v18 offset:512
    v_add_f32 v175, v175, v127
    v_add_f32 v176, v176, v128
    v_add_f32 v177, v177, v129
    v_add_f32 v178, v178, v130
    v_add_f32 v179, v179, v131
    v_add_f32 v180, v180, v132
    v_add_f32 v181, v181, v133
    v_mfma_f32_16x16x32_bf16 v[220:223], v[68:71], v[108:111], v[220:223]
    ds_read_b64_tr_b16 v[100:101], v17 offset:12288
    v_add_f32 v182, v182, v134
    v_add_f32 v183, v183, v135
    v_add_f32 v184, v184, v136
    v_add_f32 v185, v185, v137
    v_add_f32 v186, v186, v138
    v_add_f32 v187, v187, v139
    v_cvt_pk_bf16_f32 v172, v172, v173
    v_mfma_f32_16x16x32_bf16 v[228:231], v[68:71], v[112:115], v[228:231]
    ds_read_b64_tr_b16 v[102:103], v17 offset:12800
    v_cvt_pk_bf16_f32 v173, v174, v175
    v_cvt_pk_bf16_f32 v174, v176, v177
    v_cvt_pk_bf16_f32 v175, v178, v179
    v_cvt_pk_bf16_f32 v180, v180, v181
    v_cvt_pk_bf16_f32 v181, v182, v183
    v_cvt_pk_bf16_f32 v182, v184, v185
    v_cvt_pk_bf16_f32 v183, v186, v187
    v_mfma_f32_16x16x32_bf16 v[224:227], v[72:75], v[108:111], v[224:227]
    ds_read_b64_tr_b16 v[104:105], v18 offset:12288
    v_mul_f32 v124, s44, v188
    v_mul_f32 v125, s44, v189
    v_mul_f32 v126, s44, v190
    v_mul_f32 v127, s44, v191
    v_mul_f32 v128, s44, v192
    v_mul_f32 v129, s44, v193
    v_mul_f32 v130, s44, v194
    v_mul_f32 v131, s44, v195
    v_mfma_f32_16x16x32_bf16 v[232:235], v[72:75], v[112:115], v[232:235]
    ds_read_b64_tr_b16 v[106:107], v18 offset:12800
    v_mul_f32 v132, s44, v196
    v_mul_f32 v133, s44, v197
    v_mul_f32 v134, s44, v198
    v_mul_f32 v135, s44, v199
    v_mul_f32 v136, s44, v200
    v_mul_f32 v137, s44, v201
    v_mul_f32 v138, s44, v202
    v_mfma_f32_16x16x32_bf16 v[204:207], v[76:79], v[116:119], v[204:207]
    v_mul_f32 v139, s44, v203
    v_exp_f32 v124, v124 clamp
    v_max_f32 v188, s46, v188
    v_exp_f32 v125, v125 clamp
    v_max_f32 v189, s46, v189
    v_exp_f32 v126, v126 clamp
    v_max_f32 v190, s46, v190
    v_mfma_f32_16x16x32_bf16 v[212:215], v[76:79], v[120:123], v[212:215]
    v_exp_f32 v127, v127 clamp
    v_max_f32 v191, s46, v191
    v_exp_f32 v128, v128 clamp
    v_max_f32 v192, s46, v192
    v_exp_f32 v129, v129 clamp
    v_max_f32 v193, s46, v193
    v_exp_f32 v130, v130 clamp
    v_mfma_f32_16x16x32_bf16 v[208:211], v[80:83], v[116:119], v[208:211]
    v_max_f32 v194, s46, v194
    v_exp_f32 v131, v131 clamp
    v_max_f32 v195, s46, v195
    v_exp_f32 v132, v132 clamp
    v_max_f32 v196, s46, v196
    v_exp_f32 v133, v133 clamp
    v_max_f32 v197, s46, v197
    v_mfma_f32_16x16x32_bf16 v[216:219], v[80:83], v[120:123], v[216:219]
    v_exp_f32 v134, v134 clamp
    v_max_f32 v198, s46, v198
    v_exp_f32 v135, v135 clamp
    v_max_f32 v199, s46, v199
    v_exp_f32 v136, v136 clamp
    v_max_f32 v200, s46, v200
    v_exp_f32 v137, v137 clamp
    v_max_f32 v201, s46, v201
    v_mfma_f32_16x16x32_bf16 v[220:223], v[84:87], v[116:119], v[220:223]
    v_exp_f32 v138, v138 clamp
    v_max_f32 v202, s46, v202
    v_exp_f32 v139, v139 clamp
    v_max_f32 v203, s46, v203
    v_add_f32 v188, v188, v124
    v_add_f32 v189, v189, v125
    v_add_f32 v190, v190, v126
    v_mfma_f32_16x16x32_bf16 v[228:231], v[84:87], v[120:123], v[228:231]
    v_add_f32 v191, v191, v127
    v_add_f32 v192, v192, v128
    v_add_f32 v193, v193, v129
    v_add_f32 v194, v194, v130
    v_add_f32 v195, v195, v131
    v_add_f32 v196, v196, v132
    v_add_f32 v197, v197, v133
    v_mfma_f32_16x16x32_bf16 v[224:227], v[88:91], v[116:119], v[224:227]
    v_add_f32 v198, v198, v134
    v_add_f32 v199, v199, v135
    v_add_f32 v200, v200, v136
    v_add_f32 v201, v201, v137
    v_add_f32 v202, v202, v138
    v_add_f32 v203, v203, v139
    v_cvt_pk_bf16_f32 v188, v188, v189
    v_mfma_f32_16x16x32_bf16 v[232:235], v[88:91], v[120:123], v[232:235]
    v_cvt_pk_bf16_f32 v189, v190, v191
    v_cvt_pk_bf16_f32 v190, v192, v193
    v_cvt_pk_bf16_f32 v191, v194, v195
    v_cvt_pk_bf16_f32 v196, v196, v197
    v_cvt_pk_bf16_f32 v197, v198, v199
    v_cvt_pk_bf16_f32 v198, v200, v201
    v_cvt_pk_bf16_f32 v199, v202, v203
    s_setprio 0
    v_mfma_f32_16x16x32_bf16 v[140:143], v[36:39], v[20:23], v[140:143]
    v_mfma_f32_16x16x32_bf16 v[144:147], v[40:43], v[20:23], v[144:147]
    v_mfma_f32_16x16x32_bf16 v[148:151], v[36:39], v[24:27], v[148:151]
    v_mfma_f32_16x16x32_bf16 v[152:155], v[40:43], v[24:27], v[152:155]
    v_mfma_f32_16x16x32_bf16 v[156:159], v[36:39], v[28:31], v[156:159]
    v_mov_b32 v108, 0x3f803f80
    v_mov_b32 v109, 0x3f803f80
    v_mfma_f32_16x16x32_bf16 v[160:163], v[40:43], v[28:31], v[160:163]
    v_mov_b32 v110, 0x3f803f80
    v_mov_b32 v111, 0x3f803f80
    v_mfma_f32_16x16x32_bf16 v[164:167], v[36:39], v[32:35], v[164:167]
    v_cvt_pk_bf16_f32 v204, v204, v205
    v_cvt_pk_bf16_f32 v205, v206, v207
    v_mfma_f32_16x16x32_bf16 v[168:171], v[40:43], v[32:35], v[168:171]
    s_waitcnt lgkmcnt(0)
    v_cvt_pk_bf16_f32 v206, v208, v209
    v_mfma_f32_16x16x32_bf16 v[140:143], v[92:95], v[60:63], v[140:143]
    v_cvt_pk_bf16_f32 v207, v210, v211
    v_cvt_pk_bf16_f32 v212, v212, v213
    v_mfma_f32_16x16x32_bf16 v[144:147], v[96:99], v[60:63], v[144:147]
    v_cvt_pk_bf16_f32 v213, v214, v215
    v_cvt_pk_bf16_f32 v214, v216, v217
    v_mfma_f32_16x16x32_bf16 v[148:151], v[92:95], v[64:67], v[148:151]
    v_cvt_pk_bf16_f32 v215, v218, v219
    v_mfma_f32_16x16x32_bf16 v[152:155], v[96:99], v[64:67], v[152:155]
    v_mfma_f32_16x16x32_bf16 v[112:115], v[108:111], v[172:175], 0
    v_mfma_f32_16x16x32_bf16 v[116:119], v[108:111], v[180:183], 0
    v_mfma_f32_16x16x32_bf16 v[156:159], v[92:95], v[68:71], v[156:159]
    v_mfma_f32_16x16x32_bf16 v[112:115], v[108:111], v[188:191], v[112:115]
    v_mfma_f32_16x16x32_bf16 v[116:119], v[108:111], v[196:199], v[116:119]
    v_mfma_f32_16x16x32_bf16 v[160:163], v[96:99], v[68:71], v[160:163]
    v_cvt_pk_bf16_f32 v220, v220, v221
    v_mfma_f32_16x16x32_bf16 v[164:167], v[92:95], v[72:75], v[164:167]
    v_cvt_pk_bf16_f32 v221, v222, v223
    v_cvt_pk_bf16_f32 v222, v224, v225
    v_mfma_f32_16x16x32_bf16 v[168:171], v[96:99], v[72:75], v[168:171]
    v_cvt_pk_bf16_f32 v223, v226, v227
    v_cvt_pk_bf16_f32 v228, v228, v229
    v_mfma_f32_16x16x32_bf16 v[140:143], v[100:103], v[76:79], v[140:143]
    v_cvt_pk_bf16_f32 v229, v230, v231
    v_cvt_pk_bf16_f32 v230, v232, v233
    v_mfma_f32_16x16x32_bf16 v[144:147], v[104:107], v[76:79], v[144:147]
    v_cvt_pk_bf16_f32 v231, v234, v235
    v_mfma_f32_16x16x32_bf16 v[148:151], v[100:103], v[80:83], v[148:151]
    v_mfma_f32_16x16x32_bf16 v[124:127], v[172:175], v[204:207], 0
    v_mfma_f32_16x16x32_bf16 v[128:131], v[172:175], v[212:215], 0
    v_mfma_f32_16x16x32_bf16 v[152:155], v[104:107], v[80:83], v[152:155]
    v_mfma_f32_16x16x32_bf16 v[132:135], v[180:183], v[204:207], 0
    v_mfma_f32_16x16x32_bf16 v[136:139], v[180:183], v[212:215], 0
    v_mfma_f32_16x16x32_bf16 v[156:159], v[100:103], v[84:87], v[156:159]
    v_mfma_f32_16x16x32_bf16 v[124:127], v[188:191], v[220:223], v[124:127]
    v_mfma_f32_16x16x32_bf16 v[160:163], v[104:107], v[84:87], v[160:163]
    v_mfma_f32_16x16x32_bf16 v[128:131], v[188:191], v[228:231], v[128:131]
    v_mfma_f32_16x16x32_bf16 v[132:135], v[196:199], v[220:223], v[132:135]
    v_mfma_f32_16x16x32_bf16 v[164:167], v[100:103], v[88:91], v[164:167]
    v_mfma_f32_16x16x32_bf16 v[136:139], v[196:199], v[228:231], v[136:139]
    ds_write_b32 v5, v112 offset:32768
    v_mfma_f32_16x16x32_bf16 v[168:171], v[104:107], v[88:91], v[168:171]
    ds_write_b32 v5, v116 offset:32832
    s_nop 4
    ds_write_b128 v4, v[124:127] offset:0
    ds_write_b128 v4, v[128:131] offset:1024
    ds_write_b128 v4, v[132:135] offset:2048
    ds_write_b128 v4, v[136:139] offset:3072
    v_pk_mul_f32 v[20:21], v[140:141], s[44:45]
    v_pk_mul_f32 v[22:23], v[142:143], s[44:45]
    v_pk_mul_f32 v[24:25], v[144:145], s[44:45]
    v_pk_mul_f32 v[26:27], v[146:147], s[44:45]
    v_pk_mul_f32 v[28:29], v[148:149], s[44:45]
    v_pk_mul_f32 v[30:31], v[150:151], s[44:45]
    v_pk_mul_f32 v[32:33], v[152:153], s[44:45]
    v_pk_mul_f32 v[34:35], v[154:155], s[44:45]
    v_exp_f32 v20, v20 clamp
    v_max_f32 v140, s46, v140
    v_exp_f32 v21, v21 clamp
    v_max_f32 v141, s46, v141
    v_exp_f32 v22, v22 clamp
    v_max_f32 v142, s46, v142
    v_exp_f32 v23, v23 clamp
    v_max_f32 v143, s46, v143
    v_exp_f32 v24, v24 clamp
    v_max_f32 v144, s46, v144
    v_exp_f32 v25, v25 clamp
    v_max_f32 v145, s46, v145
    v_exp_f32 v26, v26 clamp
    v_max_f32 v146, s46, v146
    v_exp_f32 v27, v27 clamp
    v_max_f32 v147, s46, v147
    v_exp_f32 v28, v28 clamp
    v_max_f32 v148, s46, v148
    v_exp_f32 v29, v29 clamp
    v_max_f32 v149, s46, v149
    v_exp_f32 v30, v30 clamp
    v_max_f32 v150, s46, v150
    v_exp_f32 v31, v31 clamp
    v_max_f32 v151, s46, v151
    v_exp_f32 v32, v32 clamp
    v_max_f32 v152, s46, v152
    v_exp_f32 v33, v33 clamp
    v_max_f32 v153, s46, v153
    v_exp_f32 v34, v34 clamp
    v_max_f32 v154, s46, v154
    v_exp_f32 v35, v35 clamp
    v_max_f32 v155, s46, v155
    v_pk_add_f32 v[140:141], v[140:141], v[20:21]
    v_pk_add_f32 v[142:143], v[142:143], v[22:23]
    v_pk_add_f32 v[144:145], v[144:145], v[24:25]
    v_pk_add_f32 v[146:147], v[146:147], v[26:27]
    v_pk_add_f32 v[148:149], v[148:149], v[28:29]
    v_pk_add_f32 v[150:151], v[150:151], v[30:31]
    v_pk_add_f32 v[152:153], v[152:153], v[32:33]
    v_pk_add_f32 v[154:155], v[154:155], v[34:35]
    v_cvt_pk_bf16_f32 v140, v140, v141
    v_cvt_pk_bf16_f32 v141, v142, v143
    v_cvt_pk_bf16_f32 v142, v144, v145
    v_cvt_pk_bf16_f32 v143, v146, v147
    v_cvt_pk_bf16_f32 v148, v148, v149
    v_cvt_pk_bf16_f32 v149, v150, v151
    v_cvt_pk_bf16_f32 v150, v152, v153
    v_cvt_pk_bf16_f32 v151, v154, v155
    s_waitcnt lgkmcnt(0)
    s_barrier
    ds_read_b128 v[172:175], v8 offset:0
    ds_read_b128 v[176:179], v8 offset:4096
    ds_read_b128 v[180:183], v8 offset:8192
    ds_read_b128 v[184:187], v8 offset:12288
    ds_read_b32 v188, v9 offset:32768
    ds_read_b32 v189, v9 offset:32896
    ds_read_b32 v190, v9 offset:33024
    ds_read_b32 v191, v9 offset:33152
    v_pk_mul_f32 v[20:21], v[156:157], s[44:45]
    v_pk_mul_f32 v[22:23], v[158:159], s[44:45]
    v_pk_mul_f32 v[24:25], v[160:161], s[44:45]
    v_pk_mul_f32 v[26:27], v[162:163], s[44:45]
    v_pk_mul_f32 v[28:29], v[164:165], s[44:45]
    v_pk_mul_f32 v[30:31], v[166:167], s[44:45]
    v_pk_mul_f32 v[32:33], v[168:169], s[44:45]
    v_pk_mul_f32 v[34:35], v[170:171], s[44:45]
    v_exp_f32 v20, v20 clamp
    v_max_f32 v156, s46, v156
    v_exp_f32 v21, v21 clamp
    v_max_f32 v157, s46, v157
    v_exp_f32 v22, v22 clamp
    v_max_f32 v158, s46, v158
    v_exp_f32 v23, v23 clamp
    v_max_f32 v159, s46, v159
    v_exp_f32 v24, v24 clamp
    v_max_f32 v160, s46, v160
    v_exp_f32 v25, v25 clamp
    v_max_f32 v161, s46, v161
    v_exp_f32 v26, v26 clamp
    v_max_f32 v162, s46, v162
    v_exp_f32 v27, v27 clamp
    v_max_f32 v163, s46, v163
    v_exp_f32 v28, v28 clamp
    v_max_f32 v164, s46, v164
    v_exp_f32 v29, v29 clamp
    v_max_f32 v165, s46, v165
    v_exp_f32 v30, v30 clamp
    v_max_f32 v166, s46, v166
    v_exp_f32 v31, v31 clamp
    v_max_f32 v167, s46, v167
    v_exp_f32 v32, v32 clamp
    v_max_f32 v168, s46, v168
    v_exp_f32 v33, v33 clamp
    v_max_f32 v169, s46, v169
    v_exp_f32 v34, v34 clamp
    v_max_f32 v170, s46, v170
    v_exp_f32 v35, v35 clamp
    v_max_f32 v171, s46, v171
    v_pk_add_f32 v[156:157], v[156:157], v[20:21]
    v_pk_add_f32 v[158:159], v[158:159], v[22:23]
    v_pk_add_f32 v[160:161], v[160:161], v[24:25]
    v_pk_add_f32 v[162:163], v[162:163], v[26:27]
    v_pk_add_f32 v[164:165], v[164:165], v[28:29]
    v_pk_add_f32 v[166:167], v[166:167], v[30:31]
    v_pk_add_f32 v[168:169], v[168:169], v[32:33]
    v_pk_add_f32 v[170:171], v[170:171], v[34:35]
    v_cvt_pk_bf16_f32 v156, v156, v157
    v_cvt_pk_bf16_f32 v157, v158, v159
    v_cvt_pk_bf16_f32 v158, v160, v161
    v_cvt_pk_bf16_f32 v159, v162, v163
    v_cvt_pk_bf16_f32 v164, v164, v165
    v_cvt_pk_bf16_f32 v165, v166, v167
    v_cvt_pk_bf16_f32 v166, v168, v169
    v_cvt_pk_bf16_f32 v167, v170, v171
    s_waitcnt lgkmcnt(0)
    v_pk_add_f32 v[172:173], v[172:173], v[176:177]
    v_pk_add_f32 v[180:181], v[180:181], v[184:185]
    v_pk_add_f32 v[174:175], v[174:175], v[178:179]
    v_pk_add_f32 v[182:183], v[182:183], v[186:187]
    v_pk_add_f32 v[172:173], v[172:173], v[180:181]
    v_pk_add_f32 v[174:175], v[174:175], v[182:183]
    buffer_store_dwordx4 v[172:175], v10, s[24:27], s42 offen sc1
    s_cmp_lg_u32 s32, 0
    s_cbranch_scc1 L_k1_A_done
    v_add_f32 v188, v188, v189
    v_add_f32 v190, v190, v191
    v_add_f32 v188, v188, v190
    s_mov_b32 exec_hi, 0
    buffer_store_dword v188, v11, s[24:27], s40 offen sc1
L_k1_A_done:
    s_mov_b64 exec, -1
    s_branch L_p2
.p2align 12
.fill 768, 4, 0xbf800000
.p2align 6
L_k1_B0:
    s_waitcnt vmcnt(14)
    s_barrier
    ds_read_b128 v[60:63], v15 offset:0
    ds_read_b128 v[64:67], v15 offset:2048
    ds_read_b128 v[68:71], v15 offset:4096
    ds_read_b128 v[72:75], v15 offset:6144
    ds_read_b64_tr_b16 v[76:77], v17 offset:0
    ds_read_b64_tr_b16 v[78:79], v17 offset:512
    ds_read_b64_tr_b16 v[80:81], v18 offset:0
    ds_read_b64_tr_b16 v[82:83], v18 offset:512
    ds_read_b64_tr_b16 v[84:85], v17 offset:1024
    ds_read_b64_tr_b16 v[86:87], v17 offset:1536
    ds_read_b64_tr_b16 v[88:89], v18 offset:1024
    ds_read_b64_tr_b16 v[90:91], v18 offset:1536
    ds_read_b64_tr_b16 v[92:93], v17 offset:2048
    ds_read_b64_tr_b16 v[94:95], v17 offset:2560
    ds_read_b64_tr_b16 v[96:97], v18 offset:2048
    ds_read_b64_tr_b16 v[98:99], v18 offset:2560
    s_add_u32 m0, s34, 65536
    s_nop 0
    buffer_load_dwordx4 v8, s[16:19], s36 offen offset:0  lds
    buffer_load_dwordx4 v9, s[16:19], s36 offen offset:1024  lds
    s_mov_b32 s54, 0
    s_waitcnt lgkmcnt(0)
    v_mfma_f32_16x16x32_bf16 v[140:143], v[76:79], v[60:63], 0
    ds_read_b128 v[20:23], v16 offset:0
    buffer_load_dwordx4 v10, s[16:19], s36 offen offset:2048  lds
    v_mfma_f32_16x16x32_bf16 v[144:147], v[80:83], v[60:63], 0
    ds_read_b128 v[24:27], v16 offset:2048
    v_mfma_f32_16x16x32_bf16 v[172:175], v[84:87], v[60:63], 0
    ds_read_b128 v[28:31], v16 offset:4096
    buffer_load_dwordx4 v11, s[16:19], s36 offen offset:3072  lds
    v_mfma_f32_16x16x32_bf16 v[176:179], v[88:91], v[60:63], 0
    ds_read_b128 v[32:35], v16 offset:6144
    v_mfma_f32_16x16x32_bf16 v[184:187], v[88:91], v[64:67], 0
    ds_read_b64_tr_b16 v[36:37], v17 offset:12288
    s_add_u32 m0, s34, 69632
    s_nop 0
    buffer_load_dwordx4 v8, s[16:19], s53 offen offset:0  lds
    v_mfma_f32_16x16x32_bf16 v[180:183], v[84:87], v[64:67], 0
    ds_read_b64_tr_b16 v[38:39], v17 offset:12800
    v_mfma_f32_16x16x32_bf16 v[152:155], v[80:83], v[64:67], 0
    ds_read_b64_tr_b16 v[40:41], v18 offset:12288
    v_mfma_f32_16x16x32_bf16 v[148:151], v[76:79], v[64:67], 0
    ds_read_b64_tr_b16 v[42:43], v18 offset:12800
    buffer_load_dwordx4 v9, s[16:19], s53 offen offset:1024  lds
    v_mfma_f32_16x16x32_bf16 v[156:159], v[76:79], v[68:71], 0
    ds_read_b64_tr_b16 v[44:45], v17 offset:13312
    v_mfma_f32_16x16x32_bf16 v[160:163], v[80:83], v[68:71], 0
    ds_read_b64_tr_b16 v[46:47], v17 offset:13824
    buffer_load_dwordx4 v10, s[16:19], s53 offen offset:2048  lds
    v_mfma_f32_16x16x32_bf16 v[188:191], v[84:87], v[68:71], 0
    ds_read_b64_tr_b16 v[48:49], v18 offset:13312
    v_mfma_f32_16x16x32_bf16 v[192:195], v[88:91], v[68:71], 0
    ds_read_b64_tr_b16 v[50:51], v18 offset:13824
    buffer_load_dwordx4 v11, s[16:19], s53 offen offset:3072  lds
    s_add_u32 s36, s36, 128
    s_cmp_ge_u32 s36, 2048
    s_cselect_b32 s36, 0x40000000, s36
    s_add_u32 s53, s36, 0x10000
    v_mfma_f32_16x16x32_bf16 v[200:203], v[88:91], v[72:75], 0
    ds_read_b64_tr_b16 v[52:53], v17 offset:14336
    v_mfma_f32_16x16x32_bf16 v[196:199], v[84:87], v[72:75], 0
    ds_read_b64_tr_b16 v[54:55], v17 offset:14848
    v_mfma_f32_16x16x32_bf16 v[168:171], v[80:83], v[72:75], 0
    ds_read_b64_tr_b16 v[56:57], v18 offset:14336
    s_add_u32 m0, s35, 49152
    s_nop 0
    buffer_load_dwordx4 v12, s[20:23], s37 offen offset:0  lds
    v_mfma_f32_16x16x32_bf16 v[164:167], v[76:79], v[72:75], 0
    ds_read_b64_tr_b16 v[58:59], v18 offset:14848
    v_mfma_f32_16x16x32_bf16 v[224:227], v[72:75], v[92:95], 0
    buffer_load_dwordx4 v13, s[20:23], s37 offen offset:1024  lds
    v_mfma_f32_16x16x32_bf16 v[232:235], v[72:75], v[96:99], 0
    v_mfma_f32_16x16x32_bf16 v[228:231], v[68:71], v[96:99], 0
    buffer_load_dwordx4 v14, s[20:23], s37 offen offset:2048  lds
    s_add_u32 s37, s37, 196608
    v_add_u32 v15, 32768, v15
    v_add_u32 v16, 32768, v16
    v_mfma_f32_16x16x32_bf16 v[220:223], v[68:71], v[92:95], 0
    v_add_u32 v17, 24576, v17
    v_add_u32 v18, 24576, v18
    v_mfma_f32_16x16x32_bf16 v[208:211], v[64:67], v[92:95], 0
    v_mfma_f32_16x16x32_bf16 v[216:219], v[64:67], v[96:99], 0
    v_mfma_f32_16x16x32_bf16 v[212:215], v[60:63], v[96:99], 0
    v_mfma_f32_16x16x32_bf16 v[204:207], v[60:63], v[92:95], 0
.p2align 6
L_k1_loopB0:
    s_waitcnt lgkmcnt(0)
    s_waitcnt vmcnt(11)
    s_barrier
    v_mfma_f32_16x16x32_bf16 v[140:143], v[36:39], v[20:23], v[140:143]
    ds_read_b128 v[60:63], v15 offset:0
    s_add_u32 m0, s35, s54
    s_nop 0
    buffer_load_dwordx4 v12, s[20:23], s37 offen offset:0  lds
    v_mfma_f32_16x16x32_bf16 v[144:147], v[40:43], v[20:23], v[144:147]
    ds_read_b128 v[64:67], v15 offset:2048
    v_mfma_f32_16x16x32_bf16 v[172:175], v[44:47], v[20:23], v[172:175]
    ds_read_b128 v[68:71], v15 offset:4096
    v_mfma_f32_16x16x32_bf16 v[176:179], v[48:51], v[20:23], v[176:179]
    ds_read_b128 v[72:75], v15 offset:6144
    buffer_load_dwordx4 v13, s[20:23], s37 offen offset:1024  lds
    v_mfma_f32_16x16x32_bf16 v[184:187], v[48:51], v[24:27], v[184:187]
    ds_read_b64_tr_b16 v[76:77], v17 offset:0
    v_mfma_f32_16x16x32_bf16 v[180:183], v[44:47], v[24:27], v[180:183]
    ds_read_b64_tr_b16 v[78:79], v17 offset:512
    v_mfma_f32_16x16x32_bf16 v[152:155], v[40:43], v[24:27], v[152:155]
    ds_read_b64_tr_b16 v[80:81], v18 offset:0
    buffer_load_dwordx4 v14, s[20:23], s37 offen offset:2048  lds
    s_add_u32 s37, s37, 196608
    s_add_u32 s54, s54, 12288
    s_cmp_eq_u32 s54, 61440
    s_cselect_b32 s54, 0, s54
    v_mfma_f32_16x16x32_bf16 v[148:151], v[36:39], v[24:27], v[148:151]
    ds_read_b64_tr_b16 v[82:83], v18 offset:512
    v_mfma_f32_16x16x32_bf16 v[156:159], v[36:39], v[28:31], v[156:159]
    ds_read_b64_tr_b16 v[84:85], v17 offset:1024
    v_mfma_f32_16x16x32_bf16 v[160:163], v[40:43], v[28:31], v[160:163]
    ds_read_b64_tr_b16 v[86:87], v17 offset:1536
    s_add_u32 m0, s34, s48
    s_nop 0
    buffer_load_dwordx4 v8, s[16:19], s36 offen offset:0  lds
    v_mfma_f32_16x16x32_bf16 v[188:191], v[44:47], v[28:31], v[188:191]
    ds_read_b64_tr_b16 v[88:89], v18 offset:1024
    v_mfma_f32_16x16x32_bf16 v[192:195], v[48:51], v[28:31], v[192:195]
    ds_read_b64_tr_b16 v[90:91], v18 offset:1536
    v_mfma_f32_16x16x32_bf16 v[200:203], v[48:51], v[32:35], v[200:203]
    ds_read_b64_tr_b16 v[92:93], v17 offset:2048
    buffer_load_dwordx4 v9, s[16:19], s36 offen offset:1024  lds
    v_mfma_f32_16x16x32_bf16 v[196:199], v[44:47], v[32:35], v[196:199]
    ds_read_b64_tr_b16 v[94:95], v17 offset:2560
    v_mfma_f32_16x16x32_bf16 v[168:171], v[40:43], v[32:35], v[168:171]
    ds_read_b64_tr_b16 v[96:97], v18 offset:2048
    v_mfma_f32_16x16x32_bf16 v[164:167], v[36:39], v[32:35], v[164:167]
    ds_read_b64_tr_b16 v[98:99], v18 offset:2560
    buffer_load_dwordx4 v10, s[16:19], s36 offen offset:2048  lds
    v_mfma_f32_16x16x32_bf16 v[224:227], v[32:35], v[52:55], v[224:227]
    v_mfma_f32_16x16x32_bf16 v[232:235], v[32:35], v[56:59], v[232:235]
    v_mfma_f32_16x16x32_bf16 v[228:231], v[28:31], v[56:59], v[228:231]
    buffer_load_dwordx4 v11, s[16:19], s36 offen offset:3072  lds
    s_cmp_eq_u32 s50, 49152
    s_cselect_b32 s51, s44, s45
    v_mfma_f32_16x16x32_bf16 v[220:223], v[28:31], v[52:55], v[220:223]
    s_add_u32 s50, s50, s51
    v_add_u32 v17, s51, v17
    v_mfma_f32_16x16x32_bf16 v[208:211], v[24:27], v[52:55], v[208:211]
    v_add_u32 v18, s51, v18
    v_mfma_f32_16x16x32_bf16 v[216:219], v[24:27], v[56:59], v[216:219]
    v_mfma_f32_16x16x32_bf16 v[212:215], v[20:23], v[56:59], v[212:215]
    v_mfma_f32_16x16x32_bf16 v[204:207], v[20:23], v[52:55], v[204:207]
    s_waitcnt lgkmcnt(0)
    v_mfma_f32_16x16x32_bf16 v[140:143], v[76:79], v[60:63], v[140:143]
    ds_read_b128 v[20:23], v16 offset:0
    s_add_u32 m0, s34, s48
    s_add_u32 m0, m0, 4096
    s_nop 0
    buffer_load_dwordx4 v8, s[16:19], s53 offen offset:0  lds
    v_mfma_f32_16x16x32_bf16 v[144:147], v[80:83], v[60:63], v[144:147]
    ds_read_b128 v[24:27], v16 offset:2048
    v_mfma_f32_16x16x32_bf16 v[172:175], v[84:87], v[60:63], v[172:175]
    ds_read_b128 v[28:31], v16 offset:4096
    buffer_load_dwordx4 v9, s[16:19], s53 offen offset:1024  lds
    v_mfma_f32_16x16x32_bf16 v[176:179], v[88:91], v[60:63], v[176:179]
    ds_read_b128 v[32:35], v16 offset:6144
    v_mfma_f32_16x16x32_bf16 v[184:187], v[88:91], v[64:67], v[184:187]
    ds_read_b64_tr_b16 v[36:37], v17 offset:0
    v_mfma_f32_16x16x32_bf16 v[180:183], v[84:87], v[64:67], v[180:183]
    ds_read_b64_tr_b16 v[38:39], v17 offset:512
    buffer_load_dwordx4 v10, s[16:19], s53 offen offset:2048  lds
    v_mfma_f32_16x16x32_bf16 v[152:155], v[80:83], v[64:67], v[152:155]
    ds_read_b64_tr_b16 v[40:41], v18 offset:0
    v_mfma_f32_16x16x32_bf16 v[148:151], v[76:79], v[64:67], v[148:151]
    ds_read_b64_tr_b16 v[42:43], v18 offset:512
    v_mfma_f32_16x16x32_bf16 v[156:159], v[76:79], v[68:71], v[156:159]
    ds_read_b64_tr_b16 v[44:45], v17 offset:1024
    buffer_load_dwordx4 v11, s[16:19], s53 offen offset:3072  lds
    s_add_u32 s36, s36, 128
    s_cmp_ge_u32 s36, 2048
    s_cselect_b32 s36, 0x40000000, s36
    s_add_u32 s53, s36, 0x10000
    v_mfma_f32_16x16x32_bf16 v[160:163], v[80:83], v[68:71], v[160:163]
    ds_read_b64_tr_b16 v[46:47], v17 offset:1536
    v_mfma_f32_16x16x32_bf16 v[188:191], v[84:87], v[68:71], v[188:191]
    ds_read_b64_tr_b16 v[48:49], v18 offset:1024
    s_add_u32 m0, s35, s54
    s_nop 0
    buffer_load_dwordx4 v12, s[20:23], s37 offen offset:0  lds
    v_mfma_f32_16x16x32_bf16 v[192:195], v[88:91], v[68:71], v[192:195]
    ds_read_b64_tr_b16 v[50:51], v18 offset:1536
    v_mfma_f32_16x16x32_bf16 v[200:203], v[88:91], v[72:75], v[200:203]
    ds_read_b64_tr_b16 v[52:53], v17 offset:2048
    v_mfma_f32_16x16x32_bf16 v[196:199], v[84:87], v[72:75], v[196:199]
    ds_read_b64_tr_b16 v[54:55], v17 offset:2560
    buffer_load_dwordx4 v13, s[20:23], s37 offen offset:1024  lds
    v_mfma_f32_16x16x32_bf16 v[168:171], v[80:83], v[72:75], v[168:171]
    ds_read_b64_tr_b16 v[56:57], v18 offset:2048
    v_mfma_f32_16x16x32_bf16 v[164:167], v[76:79], v[72:75], v[164:167]
    ds_read_b64_tr_b16 v[58:59], v18 offset:2560
    v_mfma_f32_16x16x32_bf16 v[224:227], v[72:75], v[92:95], v[224:227]
    buffer_load_dwordx4 v14, s[20:23], s37 offen offset:2048  lds
    s_add_u32 s37, s37, 196608
    s_add_u32 s54, s54, 12288
    s_cmp_eq_u32 s54, 61440
    s_cselect_b32 s54, 0, s54
    s_mov_b32 s48, s49
    s_add_u32 s49, s49, 32768
    v_mfma_f32_16x16x32_bf16 v[232:235], v[72:75], v[96:99], v[232:235]
    s_cmp_eq_u32 s49, 98304
    s_cselect_b32 s49, 0, s49
    v_mfma_f32_16x16x32_bf16 v[228:231], v[68:71], v[96:99], v[228:231]
    s_sub_u32 s51, s49, s48
    v_add_u32 v15, s51, v15
    v_mfma_f32_16x16x32_bf16 v[220:223], v[68:71], v[92:95], v[220:223]
    v_add_u32 v16, s51, v16
    s_cmp_eq_u32 s50, 49152
    v_mfma_f32_16x16x32_bf16 v[208:211], v[64:67], v[92:95], v[208:211]
    s_cselect_b32 s51, s44, s45
    s_add_u32 s50, s50, s51
    v_mfma_f32_16x16x32_bf16 v[216:219], v[64:67], v[96:99], v[216:219]
    v_add_u32 v17, s51, v17
    v_add_u32 v18, s51, v18
    v_mfma_f32_16x16x32_bf16 v[212:215], v[60:63], v[96:99], v[212:215]
    s_sub_u32 s52, s52, 1
    s_cmp_lg_u32 s52, 0
    v_mfma_f32_16x16x32_bf16 v[204:207], v[60:63], v[92:95], v[204:207]
    s_cbranch_scc1 L_k1_loopB0
    s_branch L_k1_tailB
L_k1_B1:
    s_barrier
    ds_read_b128 v[60:63], v15 offset:0
    ds_read_b128 v[64:67], v15 offset:2048
    ds_read_b128 v[68:71], v15 offset:4096
    ds_read_b128 v[72:75], v15 offset:6144
    ds_read_b64_tr_b16 v[76:77], v17 offset:0
    ds_read_b64_tr_b16 v[78:79], v17 offset:512
    ds_read_b64_tr_b16 v[80:81], v18 offset:0
    ds_read_b64_tr_b16 v[82:83], v18 offset:512
    ds_read_b64_tr_b16 v[84:85], v17 offset:1024
    ds_read_b64_tr_b16 v[86:87], v17 offset:1536
    ds_read_b64_tr_b16 v[88:89], v18 offset:1024
    ds_read_b64_tr_b16 v[90:91], v18 offset:1536
    ds_read_b64_tr_b16 v[92:93], v17 offset:2048
    ds_read_b64_tr_b16 v[94:95], v17 offset:2560
    ds_read_b64_tr_b16 v[96:97], v18 offset:2048
    ds_read_b64_tr_b16 v[98:99], v18 offset:2560
    s_waitcnt lgkmcnt(0)
    v_mfma_f32_16x16x32_bf16 v[140:143], v[76:79], v[60:63], 0
    ds_read_b128 v[20:23], v16 offset:0
    v_mfma_f32_16x16x32_bf16 v[144:147], v[80:83], v[60:63], 0
    ds_read_b128 v[24:27], v16 offset:2048
    v_mfma_f32_16x16x32_bf16 v[172:175], v[84:87], v[60:63], 0
    ds_read_b128 v[28:31], v16 offset:4096
    v_mfma_f32_16x16x32_bf16 v[176:179], v[88:91], v[60:63], 0
    ds_read_b128 v[32:35], v16 offset:6144
    v_mfma_f32_16x16x32_bf16 v[184:187], v[88:91], v[64:67], 0
    ds_read_b64_tr_b16 v[36:37], v17 offset:12288
    v_mfma_f32_16x16x32_bf16 v[180:183], v[84:87], v[64:67], 0
    ds_read_b64_tr_b16 v[38:39], v17 offset:12800
    v_mfma_f32_16x16x32_bf16 v[152:155], v[80:83], v[64:67], 0
    ds_read_b64_tr_b16 v[40:41], v18 offset:12288
    v_mfma_f32_16x16x32_bf16 v[148:151], v[76:79], v[64:67], 0
    ds_read_b64_tr_b16 v[42:43], v18 offset:12800
    v_mfma_f32_16x16x32_bf16 v[156:159], v[76:79], v[68:71], 0
    ds_read_b64_tr_b16 v[44:45], v17 offset:13312
    v_mfma_f32_16x16x32_bf16 v[160:163], v[80:83], v[68:71], 0
    ds_read_b64_tr_b16 v[46:47], v17 offset:13824
    v_mfma_f32_16x16x32_bf16 v[188:191], v[84:87], v[68:71], 0
    ds_read_b64_tr_b16 v[48:49], v18 offset:13312
    v_mfma_f32_16x16x32_bf16 v[192:195], v[88:91], v[68:71], 0
    ds_read_b64_tr_b16 v[50:51], v18 offset:13824
    v_mfma_f32_16x16x32_bf16 v[200:203], v[88:91], v[72:75], 0
    ds_read_b64_tr_b16 v[52:53], v17 offset:14336
    v_mfma_f32_16x16x32_bf16 v[196:199], v[84:87], v[72:75], 0
    ds_read_b64_tr_b16 v[54:55], v17 offset:14848
    v_mfma_f32_16x16x32_bf16 v[168:171], v[80:83], v[72:75], 0
    ds_read_b64_tr_b16 v[56:57], v18 offset:14336
    v_mfma_f32_16x16x32_bf16 v[164:167], v[76:79], v[72:75], 0
    ds_read_b64_tr_b16 v[58:59], v18 offset:14848
    v_add_u32 v15, 32768, v15
    v_add_u32 v16, 32768, v16
    v_mfma_f32_16x16x32_bf16 v[224:227], v[72:75], v[92:95], 0
    v_add_u32 v17, 24576, v17
    v_add_u32 v18, 24576, v18
    v_mfma_f32_16x16x32_bf16 v[232:235], v[72:75], v[96:99], 0
    v_mfma_f32_16x16x32_bf16 v[228:231], v[68:71], v[96:99], 0
    v_mfma_f32_16x16x32_bf16 v[220:223], v[68:71], v[92:95], 0
    v_mfma_f32_16x16x32_bf16 v[208:211], v[64:67], v[92:95], 0
    v_mfma_f32_16x16x32_bf16 v[216:219], v[64:67], v[96:99], 0
    v_mfma_f32_16x16x32_bf16 v[212:215], v[60:63], v[96:99], 0
    v_mfma_f32_16x16x32_bf16 v[204:207], v[60:63], v[92:95], 0
    s_mov_b64 exec, 3
    buffer_load_dword v19, v7, s[56:59], 0 offen
    s_mov_b64 exec, -1
.p2align 6
L_k1_loopB1:
    s_waitcnt lgkmcnt(0)
    s_barrier
    v_mfma_f32_16x16x32_bf16 v[140:143], v[36:39], v[20:23], v[140:143]
    ds_read_b128 v[60:63], v15 offset:0
    v_mfma_f32_16x16x32_bf16 v[144:147], v[40:43], v[20:23], v[144:147]
    ds_read_b128 v[64:67], v15 offset:2048
    v_mfma_f32_16x16x32_bf16 v[172:175], v[44:47], v[20:23], v[172:175]
    ds_read_b128 v[68:71], v15 offset:4096
    v_mfma_f32_16x16x32_bf16 v[176:179], v[48:51], v[20:23], v[176:179]
    ds_read_b128 v[72:75], v15 offset:6144
    v_mfma_f32_16x16x32_bf16 v[184:187], v[48:51], v[24:27], v[184:187]
    ds_read_b64_tr_b16 v[76:77], v17 offset:0
    v_mfma_f32_16x16x32_bf16 v[180:183], v[44:47], v[24:27], v[180:183]
    ds_read_b64_tr_b16 v[78:79], v17 offset:512
    v_mfma_f32_16x16x32_bf16 v[152:155], v[40:43], v[24:27], v[152:155]
    ds_read_b64_tr_b16 v[80:81], v18 offset:0
    v_mfma_f32_16x16x32_bf16 v[148:151], v[36:39], v[24:27], v[148:151]
    ds_read_b64_tr_b16 v[82:83], v18 offset:512
    v_mfma_f32_16x16x32_bf16 v[156:159], v[36:39], v[28:31], v[156:159]
    ds_read_b64_tr_b16 v[84:85], v17 offset:1024
    v_mfma_f32_16x16x32_bf16 v[160:163], v[40:43], v[28:31], v[160:163]
    ds_read_b64_tr_b16 v[86:87], v17 offset:1536
    v_mfma_f32_16x16x32_bf16 v[188:191], v[44:47], v[28:31], v[188:191]
    ds_read_b64_tr_b16 v[88:89], v18 offset:1024
    v_mfma_f32_16x16x32_bf16 v[192:195], v[48:51], v[28:31], v[192:195]
    ds_read_b64_tr_b16 v[90:91], v18 offset:1536
    v_mfma_f32_16x16x32_bf16 v[200:203], v[48:51], v[32:35], v[200:203]
    ds_read_b64_tr_b16 v[92:93], v17 offset:2048
    v_mfma_f32_16x16x32_bf16 v[196:199], v[44:47], v[32:35], v[196:199]
    ds_read_b64_tr_b16 v[94:95], v17 offset:2560
    v_mfma_f32_16x16x32_bf16 v[168:171], v[40:43], v[32:35], v[168:171]
    ds_read_b64_tr_b16 v[96:97], v18 offset:2048
    v_mfma_f32_16x16x32_bf16 v[164:167], v[36:39], v[32:35], v[164:167]
    ds_read_b64_tr_b16 v[98:99], v18 offset:2560
    s_cmp_eq_u32 s50, 49152
    s_cselect_b32 s51, s44, s45
    v_mfma_f32_16x16x32_bf16 v[224:227], v[32:35], v[52:55], v[224:227]
    s_add_u32 s50, s50, s51
    v_add_u32 v17, s51, v17
    v_mfma_f32_16x16x32_bf16 v[232:235], v[32:35], v[56:59], v[232:235]
    v_add_u32 v18, s51, v18
    v_mfma_f32_16x16x32_bf16 v[228:231], v[28:31], v[56:59], v[228:231]
    v_mfma_f32_16x16x32_bf16 v[220:223], v[28:31], v[52:55], v[220:223]
    v_mfma_f32_16x16x32_bf16 v[208:211], v[24:27], v[52:55], v[208:211]
    v_mfma_f32_16x16x32_bf16 v[216:219], v[24:27], v[56:59], v[216:219]
    v_mfma_f32_16x16x32_bf16 v[212:215], v[20:23], v[56:59], v[212:215]
    v_mfma_f32_16x16x32_bf16 v[204:207], v[20:23], v[52:55], v[204:207]
    s_waitcnt lgkmcnt(0)
    v_mfma_f32_16x16x32_bf16 v[140:143], v[76:79], v[60:63], v[140:143]
    ds_read_b128 v[20:23], v16 offset:0
    v_mfma_f32_16x16x32_bf16 v[144:147], v[80:83], v[60:63], v[144:147]
    ds_read_b128 v[24:27], v16 offset:2048
    v_mfma_f32_16x16x32_bf16 v[172:175], v[84:87], v[60:63], v[172:175]
    ds_read_b128 v[28:31], v16 offset:4096
    v_mfma_f32_16x16x32_bf16 v[176:179], v[88:91], v[60:63], v[176:179]
    ds_read_b128 v[32:35], v16 offset:6144
    v_mfma_f32_16x16x32_bf16 v[184:187], v[88:91], v[64:67], v[184:187]
    ds_read_b64_tr_b16 v[36:37], v17 offset:0
    v_mfma_f32_16x16x32_bf16 v[180:183], v[84:87], v[64:67], v[180:183]
    ds_read_b64_tr_b16 v[38:39], v17 offset:512
    v_mfma_f32_16x16x32_bf16 v[152:155], v[80:83], v[64:67], v[152:155]
    ds_read_b64_tr_b16 v[40:41], v18 offset:0
    v_mfma_f32_16x16x32_bf16 v[148:151], v[76:79], v[64:67], v[148:151]
    ds_read_b64_tr_b16 v[42:43], v18 offset:512
    v_mfma_f32_16x16x32_bf16 v[156:159], v[76:79], v[68:71], v[156:159]
    ds_read_b64_tr_b16 v[44:45], v17 offset:1024
    v_mfma_f32_16x16x32_bf16 v[160:163], v[80:83], v[68:71], v[160:163]
    ds_read_b64_tr_b16 v[46:47], v17 offset:1536
    v_mfma_f32_16x16x32_bf16 v[188:191], v[84:87], v[68:71], v[188:191]
    ds_read_b64_tr_b16 v[48:49], v18 offset:1024
    v_mfma_f32_16x16x32_bf16 v[192:195], v[88:91], v[68:71], v[192:195]
    ds_read_b64_tr_b16 v[50:51], v18 offset:1536
    v_mfma_f32_16x16x32_bf16 v[200:203], v[88:91], v[72:75], v[200:203]
    ds_read_b64_tr_b16 v[52:53], v17 offset:2048
    v_mfma_f32_16x16x32_bf16 v[196:199], v[84:87], v[72:75], v[196:199]
    ds_read_b64_tr_b16 v[54:55], v17 offset:2560
    v_mfma_f32_16x16x32_bf16 v[168:171], v[80:83], v[72:75], v[168:171]
    ds_read_b64_tr_b16 v[56:57], v18 offset:2048
    v_mfma_f32_16x16x32_bf16 v[164:167], v[76:79], v[72:75], v[164:167]
    ds_read_b64_tr_b16 v[58:59], v18 offset:2560
    s_mov_b32 s48, s49
    s_add_u32 s49, s49, 32768
    v_mfma_f32_16x16x32_bf16 v[224:227], v[72:75], v[92:95], v[224:227]
    s_cmp_eq_u32 s49, 98304
    s_cselect_b32 s49, 0, s49
    v_mfma_f32_16x16x32_bf16 v[232:235], v[72:75], v[96:99], v[232:235]
    s_sub_u32 s51, s49, s48
    v_add_u32 v15, s51, v15
    v_mfma_f32_16x16x32_bf16 v[228:231], v[68:71], v[96:99], v[228:231]
    v_add_u32 v16, s51, v16
    s_cmp_eq_u32 s50, 49152
    v_mfma_f32_16x16x32_bf16 v[220:223], v[68:71], v[92:95], v[220:223]
    s_cselect_b32 s51, s44, s45
    s_add_u32 s50, s50, s51
    v_mfma_f32_16x16x32_bf16 v[208:211], v[64:67], v[92:95], v[208:211]
    v_add_u32 v17, s51, v17
    v_add_u32 v18, s51, v18
    v_mfma_f32_16x16x32_bf16 v[216:219], v[64:67], v[96:99], v[216:219]
    s_sub_u32 s52, s52, 1
    s_cmp_lg_u32 s52, 0
    v_mfma_f32_16x16x32_bf16 v[212:215], v[60:63], v[96:99], v[212:215]
    v_mfma_f32_16x16x32_bf16 v[204:207], v[60:63], v[92:95], v[204:207]
    s_cbranch_scc1 L_k1_loopB1
L_k1_tailB:
    s_waitcnt lgkmcnt(0)
    s_waitcnt vmcnt(0)
    s_barrier
    s_cmp_lg_u32 s31, 0
    s_cbranch_scc1 L_p1_notB
    v_mov_b32 v19, 0
    buffer_load_dword v236, v19, s[12:15], 0 offen sc1
L_p1_notB:
    s_setprio 2
    ds_read_b128 v[60:63], v15 offset:0
    ds_read_b128 v[64:67], v15 offset:2048
    ds_read_b128 v[68:71], v15 offset:4096
    ds_read_b128 v[72:75], v15 offset:6144
    ds_read_b64_tr_b16 v[92:93], v17 offset:0
    ds_read_b64_tr_b16 v[94:95], v17 offset:512
    ds_read_b64_tr_b16 v[96:97], v18 offset:0
    ds_read_b64_tr_b16 v[98:99], v18 offset:512
    v_mfma_f32_16x16x32_bf16 v[140:143], v[36:39], v[20:23], v[140:143]
    ds_read_b128 v[76:79], v16 offset:0
    s_lshl_b32 s40, s30, 1
    s_add_u32 s40, s40, s33
    v_mfma_f32_16x16x32_bf16 v[144:147], v[40:43], v[20:23], v[144:147]
    ds_read_b128 v[80:83], v16 offset:2048
    s_lshl_b32 s41, s29, 3
    v_mfma_f32_16x16x32_bf16 v[148:151], v[36:39], v[24:27], v[148:151]
    ds_read_b128 v[84:87], v16 offset:4096
    s_lshl_b32 s42, s32, 1
    v_mfma_f32_16x16x32_bf16 v[152:155], v[40:43], v[24:27], v[152:155]
    ds_read_b128 v[88:91], v16 offset:6144
    s_add_u32 s41, s41, s42
    v_mfma_f32_16x16x32_bf16 v[156:159], v[36:39], v[28:31], v[156:159]
    ds_read_b64_tr_b16 v[100:101], v17 offset:12288
    s_lshl_b32 s42, s40, 17
    s_lshl_b32 s41, s41, 11
    v_mfma_f32_16x16x32_bf16 v[160:163], v[40:43], v[28:31], v[160:163]
    ds_read_b64_tr_b16 v[102:103], v17 offset:12800
    s_add_u32 s42, s42, s41
    v_mfma_f32_16x16x32_bf16 v[164:167], v[36:39], v[32:35], v[164:167]
    ds_read_b64_tr_b16 v[104:105], v18 offset:12288
    s_add_u32 s41, s41, 4194304
    v_mfma_f32_16x16x32_bf16 v[168:171], v[40:43], v[32:35], v[168:171]
    ds_read_b64_tr_b16 v[106:107], v18 offset:12800
    s_waitcnt lgkmcnt(8)
    s_add_u32 s34, s30, 1
    v_mfma_f32_16x16x32_bf16 v[140:143], v[92:95], v[60:63], v[140:143]
    s_and_b32 s34, s34, s55
    s_and_b32 s36, s30, s47
    v_mfma_f32_16x16x32_bf16 v[144:147], v[96:99], v[60:63], v[144:147]
    s_or_b32 s34, s34, s36
    v_mfma_f32_16x16x32_bf16 v[148:151], v[92:95], v[64:67], v[148:151]
    s_lshl_b32 s34, s34, 1
    v_mfma_f32_16x16x32_bf16 v[152:155], v[96:99], v[64:67], v[152:155]
    s_add_u32 s34, s34, s33
    v_mfma_f32_16x16x32_bf16 v[156:159], v[92:95], v[68:71], v[156:159]
    s_lshl_b32 s34, s34, 17
    s_add_u32 s34, s34, s41
    v_mfma_f32_16x16x32_bf16 v[160:163], v[96:99], v[68:71], v[160:163]
    s_add_u32 s35, s30, 2
    v_mfma_f32_16x16x32_bf16 v[164:167], v[92:95], v[72:75], v[164:167]
    s_and_b32 s35, s35, s55
    v_mfma_f32_16x16x32_bf16 v[168:171], v[96:99], v[72:75], v[168:171]
    s_waitcnt lgkmcnt(0)
    s_and_b32 s36, s30, s47
    v_mfma_f32_16x16x32_bf16 v[140:143], v[100:103], v[76:79], v[140:143]
    ds_read_b64_tr_b16 v[108:109], v17 offset:1024
    s_or_b32 s35, s35, s36
    s_lshl_b32 s35, s35, 1
    v_mfma_f32_16x16x32_bf16 v[144:147], v[104:107], v[76:79], v[144:147]
    ds_read_b64_tr_b16 v[110:111], v17 offset:1536
    s_add_u32 s35, s35, s33
    v_mfma_f32_16x16x32_bf16 v[148:151], v[100:103], v[80:83], v[148:151]
    ds_read_b64_tr_b16 v[112:113], v18 offset:1024
    s_lshl_b32 s35, s35, 17
    v_mfma_f32_16x16x32_bf16 v[152:155], v[104:107], v[80:83], v[152:155]
    ds_read_b64_tr_b16 v[114:115], v18 offset:1536
    s_add_u32 s35, s35, s41
    v_mfma_f32_16x16x32_bf16 v[156:159], v[100:103], v[84:87], v[156:159]
    ds_read_b64_tr_b16 v[116:117], v17 offset:13312
    s_add_u32 s35, s35, 4194304
    s_mov_b32 s44, 0x3e8293ee
    v_mfma_f32_16x16x32_bf16 v[160:163], v[104:107], v[84:87], v[160:163]
    ds_read_b64_tr_b16 v[118:119], v17 offset:13824
    s_mov_b32 s45, 0x3e8293ee
    v_mfma_f32_16x16x32_bf16 v[164:167], v[100:103], v[88:91], v[164:167]
    ds_read_b64_tr_b16 v[120:121], v18 offset:13312
    v_and_b32 v4, 8, v2
    v_mfma_f32_16x16x32_bf16 v[168:171], v[104:107], v[88:91], v[168:171]
    ds_read_b64_tr_b16 v[122:123], v18 offset:13824
    v_lshl_add_u32 v7, v4, 4, v6
    s_setprio 1
    v_mfma_f32_16x16x32_bf16 v[172:175], v[44:47], v[20:23], v[172:175]
    v_mfma_f32_16x16x32_bf16 v[176:179], v[48:51], v[20:23], v[176:179]
    v_mfma_f32_16x16x32_bf16 v[180:183], v[44:47], v[24:27], v[180:183]
    v_mfma_f32_16x16x32_bf16 v[184:187], v[48:51], v[24:27], v[184:187]
    v_mfma_f32_16x16x32_bf16 v[188:191], v[44:47], v[28:31], v[188:191]
    v_mul_f32 v140, s44, v140
    v_mul_f32 v141, s44, v141
    v_mul_f32 v142, s44, v142
    v_mfma_f32_16x16x32_bf16 v[192:195], v[48:51], v[28:31], v[192:195]
    v_mul_f32 v143, s44, v143
    v_mul_f32 v144, s44, v144
    v_mul_f32 v145, s44, v145
    v_mfma_f32_16x16x32_bf16 v[196:199], v[44:47], v[32:35], v[196:199]
    v_mul_f32 v146, s44, v146
    v_mul_f32 v147, s44, v147
    v_mfma_f32_16x16x32_bf16 v[200:203], v[48:51], v[32:35], v[200:203]
    s_waitcnt lgkmcnt(0)
    v_cvt_pk_bf16_f32 v140, v140, v141
    v_cvt_pk_bf16_f32 v141, v142, v143
    v_cvt_pk_bf16_f32 v142, v144, v145
    v_mfma_f32_16x16x32_bf16 v[172:175], v[108:111], v[60:63], v[172:175]
    ds_read_b64_tr_b16 v[92:93], v17 offset:2048
    v_cvt_pk_bf16_f32 v143, v146, v147
    buffer_store_dwordx4 v[140:143], v6, s[24:27], s42 offen offset:0 sc1
    v_mfma_f32_16x16x32_bf16 v[176:179], v[112:115], v[60:63], v[176:179]
    ds_read_b64_tr_b16 v[94:95], v17 offset:2560
    v_mul_f32 v148, s44, v148
    v_mul_f32 v149, s44, v149
    v_mul_f32 v150, s44, v150
    v_mfma_f32_16x16x32_bf16 v[180:183], v[108:111], v[64:67], v[180:183]
    ds_read_b64_tr_b16 v[96:97], v18 offset:2048
    v_mul_f32 v151, s44, v151
    v_mul_f32 v152, s44, v152
    v_mul_f32 v153, s44, v153
    v_mfma_f32_16x16x32_bf16 v[184:187], v[112:115], v[64:67], v[184:187]
    ds_read_b64_tr_b16 v[98:99], v18 offset:2560
    v_mul_f32 v154, s44, v154
    v_mul_f32 v155, s44, v155
    v_mfma_f32_16x16x32_bf16 v[188:191], v[108:111], v[68:71], v[188:191]
    ds_read_b64_tr_b16 v[100:101], v17 offset:14336
    v_cvt_pk_bf16_f32 v148, v148, v149
    v_cvt_pk_bf16_f32 v149, v150, v151
    v_cvt_pk_bf16_f32 v150, v152, v153
    v_mfma_f32_16x16x32_bf16 v[192:195], v[112:115], v[68:71], v[192:195]
    ds_read_b64_tr_b16 v[102:103], v17 offset:14848
    v_cvt_pk_bf16_f32 v151, v154, v155
    buffer_store_dwordx4 v[148:151], v6, s[24:27], s42 offen offset:256 sc1
    v_mfma_f32_16x16x32_bf16 v[196:199], v[108:111], v[72:75], v[196:199]
    ds_read_b64_tr_b16 v[104:105], v18 offset:14336
    v_mul_f32 v156, s44, v156
    v_mul_f32 v157, s44, v157
    v_mul_f32 v158, s44, v158
    v_mfma_f32_16x16x32_bf16 v[200:203], v[112:115], v[72:75], v[200:203]
    ds_read_b64_tr_b16 v[106:107], v18 offset:14848
    v_mul_f32 v159, s44, v159
    v_mul_f32 v160, s44, v160
    v_mul_f32 v161, s44, v161
    v_mfma_f32_16x16x32_bf16 v[172:175], v[116:119], v[76:79], v[172:175]
    v_mul_f32 v162, s44, v162
    v_mul_f32 v163, s44, v163
    v_mfma_f32_16x16x32_bf16 v[176:179], v[120:123], v[76:79], v[176:179]
    v_cvt_pk_bf16_f32 v156, v156, v157
    v_cvt_pk_bf16_f32 v157, v158, v159
    v_cvt_pk_bf16_f32 v158, v160, v161
    v_mfma_f32_16x16x32_bf16 v[180:183], v[116:119], v[80:83], v[180:183]
    v_cvt_pk_bf16_f32 v159, v162, v163
    buffer_store_dwordx4 v[156:159], v6, s[24:27], s42 offen offset:2048 sc1
    v_mfma_f32_16x16x32_bf16 v[184:187], v[120:123], v[80:83], v[184:187]
    v_mul_f32 v164, s44, v164
    v_mul_f32 v165, s44, v165
    v_mul_f32 v166, s44, v166
    v_mfma_f32_16x16x32_bf16 v[188:191], v[116:119], v[84:87], v[188:191]
    v_mul_f32 v167, s44, v167
    v_mul_f32 v168, s44, v168
    v_mul_f32 v169, s44, v169
    v_mfma_f32_16x16x32_bf16 v[192:195], v[120:123], v[84:87], v[192:195]
    v_mul_f32 v170, s44, v170
    v_mul_f32 v171, s44, v171
    v_mfma_f32_16x16x32_bf16 v[196:199], v[116:119], v[88:91], v[196:199]
    v_cvt_pk_bf16_f32 v164, v164, v165
    v_cvt_pk_bf16_f32 v165, v166, v167
    v_cvt_pk_bf16_f32 v166, v168, v169
    v_mfma_f32_16x16x32_bf16 v[200:203], v[120:123], v[88:91], v[200:203]
    v_cvt_pk_bf16_f32 v167, v170, v171
    buffer_store_dwordx4 v[164:167], v6, s[24:27], s42 offen offset:2304 sc1
    s_setprio 0
    v_mfma_f32_16x16x32_bf16 v[204:207], v[20:23], v[52:55], v[204:207]
    v_mfma_f32_16x16x32_bf16 v[212:215], v[20:23], v[56:59], v[212:215]
    v_mfma_f32_16x16x32_bf16 v[208:211], v[24:27], v[52:55], v[208:211]
    v_mfma_f32_16x16x32_bf16 v[216:219], v[24:27], v[56:59], v[216:219]
    v_mfma_f32_16x16x32_bf16 v[220:223], v[28:31], v[52:55], v[220:223]
    v_cvt_pk_bf16_f32 v172, v172, v173
    v_mfma_f32_16x16x32_bf16 v[228:231], v[28:31], v[56:59], v[228:231]
    v_cvt_pk_bf16_f32 v173, v174, v175
    v_mfma_f32_16x16x32_bf16 v[224:227], v[32:35], v[52:55], v[224:227]
    v_cvt_pk_bf16_f32 v174, v176, v177
    v_mfma_f32_16x16x32_bf16 v[232:235], v[32:35], v[56:59], v[232:235]
    s_waitcnt lgkmcnt(0)
    v_cvt_pk_bf16_f32 v175, v178, v179
    v_mfma_f32_16x16x32_bf16 v[204:207], v[60:63], v[92:95], v[204:207]
    buffer_store_dwordx4 v[172:175], v7, s[24:27], s34 offen offset:0 sc1
    v_mfma_f32_16x16x32_bf16 v[212:215], v[60:63], v[96:99], v[212:215]
    v_cvt_pk_bf16_f32 v180, v180, v181
    v_mfma_f32_16x16x32_bf16 v[208:211], v[64:67], v[92:95], v[208:211]
    v_cvt_pk_bf16_f32 v181, v182, v183
    v_mfma_f32_16x16x32_bf16 v[216:219], v[64:67], v[96:99], v[216:219]
    v_cvt_pk_bf16_f32 v182, v184, v185
    v_mfma_f32_16x16x32_bf16 v[220:223], v[68:71], v[92:95], v[220:223]
    v_cvt_pk_bf16_f32 v183, v186, v187
    v_mfma_f32_16x16x32_bf16 v[228:231], v[68:71], v[96:99], v[228:231]
    buffer_store_dwordx4 v[180:183], v7, s[24:27], s34 offen offset:128 sc1
    v_mfma_f32_16x16x32_bf16 v[224:227], v[72:75], v[92:95], v[224:227]
    v_cvt_pk_bf16_f32 v188, v188, v189
    v_mfma_f32_16x16x32_bf16 v[232:235], v[72:75], v[96:99], v[232:235]
    v_cvt_pk_bf16_f32 v189, v190, v191
    v_mfma_f32_16x16x32_bf16 v[204:207], v[76:79], v[100:103], v[204:207]
    v_cvt_pk_bf16_f32 v190, v192, v193
    v_mfma_f32_16x16x32_bf16 v[212:215], v[76:79], v[104:107], v[212:215]
    v_cvt_pk_bf16_f32 v191, v194, v195
    v_mfma_f32_16x16x32_bf16 v[208:211], v[80:83], v[100:103], v[208:211]
    buffer_store_dwordx4 v[188:191], v7, s[24:27], s34 offen offset:2048 sc1
    v_mfma_f32_16x16x32_bf16 v[216:219], v[80:83], v[104:107], v[216:219]
    v_cvt_pk_bf16_f32 v196, v196, v197
    v_mfma_f32_16x16x32_bf16 v[220:223], v[84:87], v[100:103], v[220:223]
    v_cvt_pk_bf16_f32 v197, v198, v199
    v_mfma_f32_16x16x32_bf16 v[228:231], v[84:87], v[104:107], v[228:231]
    v_cvt_pk_bf16_f32 v198, v200, v201
    v_mfma_f32_16x16x32_bf16 v[224:227], v[88:91], v[100:103], v[224:227]
    v_cvt_pk_bf16_f32 v199, v202, v203
    v_mfma_f32_16x16x32_bf16 v[232:235], v[88:91], v[104:107], v[232:235]
    buffer_store_dwordx4 v[196:199], v7, s[24:27], s34 offen offset:2176 sc1
    s_nop 3
    v_cvt_pk_bf16_f32 v204, v204, v205
    v_cvt_pk_bf16_f32 v205, v206, v207
    v_cvt_pk_bf16_f32 v206, v208, v209
    v_cvt_pk_bf16_f32 v207, v210, v211
    buffer_store_dwordx4 v[204:207], v6, s[24:27], s35 offen offset:0 sc1
    v_cvt_pk_bf16_f32 v212, v212, v213
    v_cvt_pk_bf16_f32 v213, v214, v215
    v_cvt_pk_bf16_f32 v214, v216, v217
    v_cvt_pk_bf16_f32 v215, v218, v219
    buffer_store_dwordx4 v[212:215], v6, s[24:27], s35 offen offset:256 sc1
    v_cvt_pk_bf16_f32 v220, v220, v221
    v_cvt_pk_bf16_f32 v221, v222, v223
    v_cvt_pk_bf16_f32 v222, v224, v225
    v_cvt_pk_bf16_f32 v223, v226, v227
    buffer_store_dwordx4 v[220:223], v6, s[24:27], s35 offen offset:2048 sc1
    v_cvt_pk_bf16_f32 v228, v228, v229
    v_cvt_pk_bf16_f32 v229, v230, v231
    v_cvt_pk_bf16_f32 v230, v232, v233
    v_cvt_pk_bf16_f32 v231, v234, v235
    buffer_store_dwordx4 v[228:231], v6, s[24:27], s35 offen offset:2304 sc1
    s_nop 1
.p2align 6
L_p2:
    s_and_b32 s4, s2, 7
    s_lshr_b32 s5, s2, 3
    s_lshl_b32 s20, s4, 2
    s_and_b32 s6, s5, 3
    s_add_u32 s20, s20, s6
    s_lshr_b32 s21, s5, 2
    s_lshl_b32 s22, s21, 3
    s_add_u32 s22, s22, s31
    v_lshlrev_b32 v2, 4, v1
    s_lshl_b32 s28, s31, 11
    s_lshl_b32 s3, s20, 17
    s_add_u32 s3, s3, 4194304
    s_and_b32 s6, s31, 1
    s_lshl_b32 s6, s6, 22
    s_add_u32 s6, s6, s3
    s_add_u32 s16, s24, s6
    s_addc_u32 s17, s25, 0
    s_mov_b32 s18, 0x20000
    s_mov_b32 s19, 0x20000
    s_lshr_b32 s23, s31, 1
    s_lshl_b32 s23, s23, 11
    s_lshl_b32 s8, s20, 17
    s_lshl_b32 s7, s22, 11
    s_add_u32 s8, s8, s7
    s_add_u32 s35, s8, 12582912
    s_lshr_b32 s32, s20, 3
    s_lshl_b32 s32, s32, 12
    s_add_u32 s32, s32, 18874368
    s_add_u32 s51, s32, 16384
    s_lshr_b32 s6, s20, 1
    v_lshrrev_b32 v3, 3, v1
    v_min_u32 v3, 2, v3
    v_cmp_eq_u32 vcc, 2, v3
    v_add_u32 v3, 1, v3
    v_and_b32 v4, 7, v1
    v_mov_b32 v5, s21
    v_cndmask_b32 v4, v4, v5, vcc
    v_mov_b32 v5, 0
    v_cndmask_b32 v3, v3, v5, vcc
    v_sub_u32 v3, s6, v3
    v_and_b32 v5, 3, v3
    v_lshl_add_u32 v5, v5, 3, v4
    v_lshlrev_b32 v194, 7, v5
    v_lshlrev_b32 v195, 7, v5
    s_cmp_eq_u32 s61, 0
    s_cbranch_scc1 L_p2_x1
    s_waitcnt vmcnt(0)
L_p2_x1:
    s_waitcnt lgkmcnt(0)
    s_barrier
    s_cmp_eq_u32 s31, 0
    s_cbranch_scc0 L_p2_x2
    s_mov_b32 s55, 262144
L_p2_tag:
    s_waitcnt vmcnt(0)
    v_cmp_ne_u32 vcc, 0, v236
    s_sub_u32 s55, s55, 1
    s_cbranch_scc1 L_p2_tagok
    s_cbranch_vccnz L_p2_tagok
    v_mov_b32 v3, 0
    buffer_load_dword v236, v3, s[12:15], 0 offen sc1
    s_branch L_p2_tag
L_p2_tagok:
    s_cmp_eq_u32 s61, 0
    s_cbranch_scc1 L_p2_nof
    v_mov_b32 v3, 0
    s_mov_b64 exec, 1
    buffer_store_dword v236, v3, s[24:27], s60 offen offset:0 sc1
    s_mov_b64 exec, -1
L_p2_nof:
    s_mov_b32 s55, 262144
L_p2_w_chk:
    buffer_load_dword v191, v195, s[24:27], s51 offen sc1
    s_sub_u32 s55, s55, 1
    s_cmp_eq_u32 s55, 0
    s_cbranch_scc1 L_p2_w_ok
    s_waitcnt vmcnt(0)
L_p2_w_cmp:
    v_cmp_eq_u32 vcc, v236, v191
    s_cmp_eq_u64 vcc, -1
    s_cbranch_scc1 L_p2_w_ok
    s_sleep 0
    s_branch L_p2_w_chk
L_p2_w_ok:
L_p2_x2:
    s_barrier
    s_add_u32 m0, s28, 98304
    s_nop 0
    buffer_load_dwordx4 v2, s[16:19], s23 offen sc1 lds
    buffer_load_dwordx4 v2, s[16:19], s23 offen offset:1024 sc1 lds
    s_add_u32 s23, s23, 8192
    buffer_load_dwordx4 v[8:11], v2, s[24:27], s8 offen sc1
    buffer_load_dwordx4 v[12:15], v2, s[24:27], s8 offen offset:1024 sc1
    s_add_u32 m0, s28, 114688
    s_nop 0
    buffer_load_dwordx4 v2, s[16:19], s23 offen sc1 lds
    buffer_load_dwordx4 v2, s[16:19], s23 offen offset:1024 sc1 lds
    s_add_u32 s23, s23, 8192
    s_and_b32 s4, s2, 7
    s_lshr_b32 s5, s2, 3
    v_add_u32 v188, 98304, v2
    v_add_u32 v189, 131072, v2
    s_add_u32 s44, s28, 98304
    s_mov_b32 s56, s98
    s_mov_b32 s57, s99
    s_mov_b32 s58, 0x800000
    s_mov_b32 s59, 0x20000
    s_lshr_b32 s29, s4, 2
    s_cmp_eq_u32 s29, 0
    s_cselect_b32 s36, s62, s96
    s_cselect_b32 s37, s63, s97
    s_mov_b32 s38, 0x200000
    s_mov_b32 s39, 0x20000
    s_and_b32 s52, s4, 1
    s_lshl_b32 s52, s52, 3
    s_and_b32 s6, s5, 7
    s_add_u32 s52, s52, s6
    s_bfe_u32 s4, s4, 0x10001
    s_lshl_b32 s55, s4, 2
    s_lshr_b32 s6, s5, 3
    s_add_u32 s55, s55, s6
    s_lshl_b32 s5, s5, 2
    s_add_u32 s5, s5, s31
    s_lshl_b32 s5, s5, 14
    s_lshl_b32 s4, s4, 10
    s_add_u32 s5, s5, s4
    v_lshrrev_b32 v3, 3, v1
    v_and_b32 v4, 7, v1
    v_lshlrev_b32 v5, 7, v4
    v_lshl_add_u32 v5, v3, 11, v5
    v_add_u32 v187, s5, v5
    s_and_b32 s4, s31, 3
    v_lshrrev_b32 v5, 4, v1
    v_and_b32 v4, 15, v1
    v_lshlrev_b32 v6, 1, v5
    v_xor_b32 v6, v6, v4
    v_lshlrev_b32 v6, 4, v6
    v_lshl_add_u32 v201, v5, 11, v6
    v_xor_b32 v6, 128, v201
    v_add_u32 v202, 7168, v6
    v_add_u32 v203, 14336, v201
    v_add_u32 v204, 21504, v6
    s_lshl_b32 s49, s4, 15
    s_lshl_b32 s5, s55, 8
    s_add_u32 s49, s49, s5
    s_lshl_b32 s48, s52, 2
    s_add_u32 s48, s48, s4
    s_lshl_b32 s48, s48, 16
    s_lshl_b32 s5, s29, 22
    s_add_u32 s48, s48, s5
    s_add_u32 s48, s48, 20971520
    s_lshl_b32 s54, s4, 12
    s_mov_b32 s50, s54
    s_lshl_b32 s46, s21, 5
    s_add_u32 s46, s46, s20
    s_lshl_b32 s46, s46, 7
    s_add_u32 s46, s46, 18907136
    s_lshr_b32 s47, s52, 1
    s_lshl_b32 s47, s47, 12
    s_lshl_b32 s5, s29, 15
    s_add_u32 s47, s47, s5
    s_add_u32 s47, s47, 18907136
    v_and_b32 v192, 31, v1
    v_lshlrev_b32 v192, 7, v192
    s_mov_b32 s10, 0x901
    s_cmp_eq_u32 s31, 0
    s_cselect_b32 s10, 0x43020901, s10
    s_cmp_ge_u32 s31, 4
    s_cselect_b32 s10, 0x10, s10
    s_mov_b32 s11, 0x70605
    s_cmp_eq_u32 s31, 0
    s_cselect_b32 s11, 0x80070605, s11
    s_cmp_ge_u32 s31, 4
    s_cselect_b32 s11, 0x706050, s11
    v_lshlrev_b32 v6, 4, v4
    v_lshl_add_u32 v6, v5, 9, v6
    s_and_b32 s5, s4, 1
    s_lshl_b32 s6, s5, 13
    s_add_u32 s6, s6, 98304
    v_add_u32 v196, s6, v6
    v_lshlrev_b32 v193, 12, v4
    v_and_b32 v6, 1, v5
    v_lshl_add_u32 v193, v6, 5, v193
    v_lshrrev_b32 v6, 1, v5
    v_lshl_add_u32 v193, v6, 4, v193
    s_lshl_b32 s53, s52, 19
    s_lshl_b32 s5, s5, 18
    s_add_u32 s53, s53, s5
    s_lshl_b32 s5, s29, 11
    s_add_u32 s53, s53, s5
    s_lshl_b32 s5, s55, 8
    s_add_u32 s53, s53, s5
    s_lshr_b32 s4, s4, 1
    s_lshl_b32 s5, s4, 7
    s_add_u32 s53, s53, s5
    v_bfe_u32 v4, v1, 2, 3
    v_lshrrev_b32 v6, 5, v1
    v_lshl_add_u32 v6, v6, 4, v4
    v_lshlrev_b32 v6, 8, v6
    v_and_b32 v3, 3, v1
    v_lshl_add_u32 v6, v3, 3, v6
    s_lshl_b32 s4, s4, 2
    v_xor_b32 v4, s4, v4
    v_lshl_add_u32 v197, v4, 5, v6
    v_xor_b32 v198, 32, v197
    v_xor_b32 v199, 64, v197
    v_xor_b32 v200, 96, v197
    s_and_b32 s4, s31, 3
    s_lshl_b32 s33, s20, 15
    s_lshl_b32 s7, s4, 13
    s_add_u32 s33, s33, s7
    s_add_u32 s33, s33, 16777216
    s_lshl_b32 s34, s20, 13
    s_and_b32 s7, s4, 1
    s_lshl_b32 s7, s7, 6
    s_add_u32 s34, s34, s7
    s_lshr_b32 s7, s4, 1
    s_lshl_b32 s7, s7, 5
    s_add_u32 s34, s34, s7
    s_add_u32 s34, s34, 17825792
    v_lshrrev_b32 v184, 5, v1
    v_lshlrev_b32 v184, 4, v184
    s_cmp_ge_u32 s31, 4
    s_cselect_b32 s33, s34, s33
    s_cbranch_scc1 L_p2_zq
    v_mov_b32 v184, v2
L_p2_zq:
    s_add_u32 s34, s33, 4096
    v_and_b32 v6, 14, v1
    v_mov_b32 v5, 0x3f803f80
    v_mov_b32 v4, 0
    v_cmp_eq_u32 vcc, 0, v6
    v_and_b32 v185, 1, v1
    v_mul_u32_u24 v185, 0xaaaa, v185
    v_cndmask_b32 v48, v4, v5, vcc
    v_cndmask_b32 v49, v4, v5, vcc
    v_cmp_eq_u32 vcc, 4, v6
    v_add_u32 v185, 0x4444, v185
    s_nop 0
    v_cndmask_b32 v50, v4, v5, vcc
    v_cndmask_b32 v51, v4, v5, vcc
    s_lshl_b32 s30, s22, 16
    s_lshl_b32 s4, s20, 11
    s_add_u32 s30, s30, s4
    s_add_u32 s30, s30, 20971520
    s_lshr_b32 s4, s31, 1
    s_lshl_b32 s4, s4, 10
    s_and_b32 s5, s31, 1
    s_lshl_b32 s5, s5, 3
    s_add_u32 s4, s4, s5
    s_add_u32 s4, s4, 81920
    v_add_u32 v186, s4, v2
    v_mov_b32 v72, 0
    v_mov_b32 v73, 0
    v_mov_b32 v74, 0
    v_mov_b32 v75, 0
    v_mov_b32 v76, 0
    v_mov_b32 v77, 0
    v_mov_b32 v78, 0
    v_mov_b32 v79, 0
    v_mov_b32 v80, 0
    v_mov_b32 v81, 0
    v_mov_b32 v82, 0
    v_mov_b32 v83, 0
    v_mov_b32 v84, 0
    v_mov_b32 v85, 0
    v_mov_b32 v86, 0
    v_mov_b32 v87, 0
    v_mov_b32 v52, 0
    v_mov_b32 v40, 0
    v_mov_b32 v44, 0
    v_mov_b32 v36, 0
    v_mov_b32 v53, 0
    v_mov_b32 v41, 0
    v_mov_b32 v45, 0
    v_mov_b32 v37, 0
    v_mov_b32 v54, 0
    v_mov_b32 v42, 0
    v_mov_b32 v46, 0
    v_mov_b32 v38, 0
    v_mov_b32 v55, 0
    v_mov_b32 v43, 0
    v_mov_b32 v47, 0
    v_mov_b32 v39, 0
    s_mov_b32 s29, 8
    s_mov_b32 s9, 0
    s_waitcnt vmcnt(2)
    s_barrier
    ds_read_b128 v[104:107], v188 offset:0
    ds_read_b128 v[108:111], v188 offset:1024
    ds_read_b128 v[24:27], v188 offset:4096
    ds_read_b128 v[28:31], v188 offset:5120
    ds_read_b128 v[32:35], v188 offset:2048
    s_waitcnt lgkmcnt(3)
    v_mfma_f32_32x32x16_bf16 v[88:103], v[104:107], v[8:11], 0
    v_mfma_f32_32x32x16_bf16 v[88:103], v[108:111], v[12:15], v[88:103]
    s_add_u32 m0, s28, 131072
    s_nop 0
    buffer_load_dwordx4 v2, s[16:19], s23 offen sc1 lds
    buffer_load_dwordx4 v2, s[16:19], s23 offen offset:1024 sc1 lds
    s_add_u32 s23, s23, 8192
    s_nop 6
    v_max3_f32 v3, v88, v89, v90
    v_max3_f32 v4, v91, v92, v93
    v_max3_f32 v5, v94, v95, v96
    v_max3_f32 v6, v97, v98, v99
    v_max3_f32 v3, v3, v100, v101
    v_max3_f32 v4, v4, v102, v103
    v_max3_f32 v3, v3, v5, v6
    v_max_f32 v3, v3, v4
    v_mov_b32 v4, v3
    s_nop 1
    v_permlane32_swap_b32 v3, v4
    v_max_f32 v3, v3, v4
    v_sub_f32 v56, 0, v3
    v_sub_f32 v57, 0, v3
    v_sub_f32 v58, 0, v3
    v_sub_f32 v59, 0, v3
    v_sub_f32 v60, 0, v3
    v_sub_f32 v61, 0, v3
    v_sub_f32 v62, 0, v3
    v_sub_f32 v63, 0, v3
    v_sub_f32 v64, 0, v3
    v_sub_f32 v65, 0, v3
    v_sub_f32 v66, 0, v3
    v_sub_f32 v67, 0, v3
    v_sub_f32 v68, 0, v3
    v_sub_f32 v69, 0, v3
    v_sub_f32 v70, 0, v3
    v_sub_f32 v71, 0, v3
    v_sub_f32 v88, v88, v3
    v_sub_f32 v89, v89, v3
    v_sub_f32 v90, v90, v3
    v_sub_f32 v91, v91, v3
    v_sub_f32 v92, v92, v3
    v_sub_f32 v93, v93, v3
    v_sub_f32 v94, v94, v3
    v_sub_f32 v95, v95, v3
    v_sub_f32 v96, v96, v3
    v_sub_f32 v97, v97, v3
    v_sub_f32 v98, v98, v3
    v_sub_f32 v99, v99, v3
    v_sub_f32 v100, v100, v3
    v_sub_f32 v101, v101, v3
    v_sub_f32 v102, v102, v3
    v_sub_f32 v103, v103, v3
    s_mov_b32 s8, 0x07060302
.p2align 6
L_k2_loop:
    s_waitcnt lgkmcnt(0)
    v_mfma_f32_32x32x16_bf16 v[104:119], v[24:27], v[8:11], v[56:71]
    s_setprio 1
    v_exp_f32 v88, v88
    v_exp_f32 v89, v89
    v_exp_f32 v90, v90
    v_exp_f32 v91, v91
    v_mfma_f32_32x32x16_bf16 v[72:87], v[36:39], v[44:47], v[72:87]
    v_exp_f32 v92, v92
    v_exp_f32 v93, v93
    v_exp_f32 v94, v94
    v_exp_f32 v95, v95
    v_smfmac_f32_16x16x64_bf16 v[52:55], v[48:51], v[40:47], v185
    v_cvt_pk_bf16_f32 v40, v88, v89
    v_cvt_pk_bf16_f32 v41, v90, v91
    v_cvt_pk_bf16_f32 v42, v92, v93
    v_cvt_pk_bf16_f32 v43, v94, v95
    v_mfma_f32_32x32x16_bf16 v[104:119], v[28:31], v[12:15], v[104:119]
    ds_read_b128 v[24:27], v188 offset:8192
    ds_read_b128 v[36:39], v188 offset:3072
    ds_read_b128 v[28:31], v188 offset:9216
    v_exp_f32 v96, v96
    v_exp_f32 v97, v97
    v_exp_f32 v98, v98
    v_exp_f32 v99, v99
    v_mfma_f32_32x32x16_bf16 v[72:87], v[32:35], v[40:43], v[72:87]
    ds_read_b128 v[32:35], v188 offset:6144
    v_cvt_pk_bf16_f32 v44, v96, v97
    v_cvt_pk_bf16_f32 v45, v98, v99
    v_exp_f32 v100, v100
    v_exp_f32 v101, v101
    v_exp_f32 v102, v102
    v_exp_f32 v103, v103
    v_cvt_pk_bf16_f32 v46, v100, v101
    v_cvt_pk_bf16_f32 v47, v102, v103
    s_waitcnt lgkmcnt(0)
    v_mfma_f32_32x32x16_bf16 v[88:103], v[24:27], v[8:11], v[56:71]
    s_setprio 0
    v_exp_f32 v104, v104
    v_exp_f32 v105, v105
    v_exp_f32 v106, v106
    v_exp_f32 v107, v107
    v_mfma_f32_32x32x16_bf16 v[72:87], v[36:39], v[44:47], v[72:87]
    v_exp_f32 v108, v108
    v_exp_f32 v109, v109
    v_exp_f32 v110, v110
    v_exp_f32 v111, v111
    v_smfmac_f32_16x16x64_bf16 v[52:55], v[48:51], v[40:47], v185
    v_cvt_pk_bf16_f32 v40, v104, v105
    v_cvt_pk_bf16_f32 v41, v106, v107
    v_cvt_pk_bf16_f32 v42, v108, v109
    v_cvt_pk_bf16_f32 v43, v110, v111
    v_mfma_f32_32x32x16_bf16 v[88:103], v[28:31], v[12:15], v[88:103]
    ds_read_b128 v[24:27], v188 offset:12288
    ds_read_b128 v[36:39], v188 offset:7168
    ds_read_b128 v[28:31], v188 offset:13312
    v_exp_f32 v112, v112
    v_exp_f32 v113, v113
    v_exp_f32 v114, v114
    v_exp_f32 v115, v115
    v_mfma_f32_32x32x16_bf16 v[72:87], v[32:35], v[40:43], v[72:87]
    ds_read_b128 v[32:35], v188 offset:10240
    v_cvt_pk_bf16_f32 v44, v112, v113
    v_cvt_pk_bf16_f32 v45, v114, v115
    v_exp_f32 v116, v116
    v_exp_f32 v117, v117
    v_exp_f32 v118, v118
    v_exp_f32 v119, v119
    v_cvt_pk_bf16_f32 v46, v116, v117
    v_cvt_pk_bf16_f32 v47, v118, v119
    s_waitcnt lgkmcnt(0)
    v_mfma_f32_32x32x16_bf16 v[104:119], v[24:27], v[8:11], v[56:71]
    s_cmp_lg_u32 s9, 0
    s_cbranch_scc1 L_k2_nw2
    s_waitcnt vmcnt(2)
L_k2_nw2:
    s_barrier
    s_setprio 3
    v_exp_f32 v88, v88
    v_exp_f32 v89, v89
    v_exp_f32 v90, v90
    v_exp_f32 v91, v91
    v_mfma_f32_32x32x16_bf16 v[72:87], v[36:39], v[44:47], v[72:87]
    v_exp_f32 v92, v92
    v_exp_f32 v93, v93
    v_exp_f32 v94, v94
    v_exp_f32 v95, v95
    v_smfmac_f32_16x16x64_bf16 v[52:55], v[48:51], v[40:47], v185
    s_xor_b32 m0, s44, 0x3c000
    s_nop 0
    buffer_load_dwordx4 v2, s[16:19], s23 offen sc1 lds
    buffer_load_dwordx4 v2, s[16:19], s23 offen offset:1024 sc1 lds
    s_add_u32 s23, s23, 8192
    v_cvt_pk_bf16_f32 v40, v88, v89
    v_cvt_pk_bf16_f32 v41, v90, v91
    v_cvt_pk_bf16_f32 v42, v92, v93
    v_cvt_pk_bf16_f32 v43, v94, v95
    v_mfma_f32_32x32x16_bf16 v[104:119], v[28:31], v[12:15], v[104:119]
    ds_read_b128 v[24:27], v188 offset:16384
    ds_read_b128 v[36:39], v188 offset:11264
    ds_read_b128 v[28:31], v188 offset:17408
    v_exp_f32 v96, v96
    v_exp_f32 v97, v97
    v_exp_f32 v98, v98
    v_exp_f32 v99, v99
    v_mfma_f32_32x32x16_bf16 v[72:87], v[32:35], v[40:43], v[72:87]
    ds_read_b128 v[32:35], v188 offset:14336
    v_cvt_pk_bf16_f32 v44, v96, v97
    v_cvt_pk_bf16_f32 v45, v98, v99
    v_exp_f32 v100, v100
    v_exp_f32 v101, v101
    v_exp_f32 v102, v102
    v_exp_f32 v103, v103
    v_cvt_pk_bf16_f32 v46, v100, v101
    v_cvt_pk_bf16_f32 v47, v102, v103
    s_and_b32 s9, s10, 15
    s_cbranch_scc1 L_k2_hook3
L_k2_hooked3:
    s_lshr_b64 s[10:11], s[10:11], 4
    s_waitcnt lgkmcnt(0)
    v_mfma_f32_32x32x16_bf16 v[88:103], v[24:27], v[8:11], v[56:71]
    s_setprio 2
    v_exp_f32 v104, v104
    v_exp_f32 v105, v105
    v_exp_f32 v106, v106
    v_exp_f32 v107, v107
    v_mfma_f32_32x32x16_bf16 v[72:87], v[36:39], v[44:47], v[72:87]
    v_exp_f32 v108, v108
    v_exp_f32 v109, v109
    v_exp_f32 v110, v110
    v_exp_f32 v111, v111
    v_smfmac_f32_16x16x64_bf16 v[52:55], v[48:51], v[40:47], v185
    v_cvt_pk_bf16_f32 v40, v104, v105
    v_cvt_pk_bf16_f32 v41, v106, v107
    v_cvt_pk_bf16_f32 v42, v108, v109
    v_cvt_pk_bf16_f32 v43, v110, v111
    v_mfma_f32_32x32x16_bf16 v[88:103], v[28:31], v[12:15], v[88:103]
    ds_read_b128 v[24:27], v188 offset:20480
    ds_read_b128 v[36:39], v188 offset:15360
    ds_read_b128 v[28:31], v188 offset:21504
    v_exp_f32 v112, v112
    v_exp_f32 v113, v113
    v_exp_f32 v114, v114
    v_exp_f32 v115, v115
    v_mfma_f32_32x32x16_bf16 v[72:87], v[32:35], v[40:43], v[72:87]
    ds_read_b128 v[32:35], v188 offset:18432
    v_cvt_pk_bf16_f32 v44, v112, v113
    v_cvt_pk_bf16_f32 v45, v114, v115
    v_exp_f32 v116, v116
    v_exp_f32 v117, v117
    v_exp_f32 v118, v118
    v_exp_f32 v119, v119
    v_cvt_pk_bf16_f32 v46, v116, v117
    v_cvt_pk_bf16_f32 v47, v118, v119
    s_waitcnt lgkmcnt(0)
    v_mfma_f32_32x32x16_bf16 v[104:119], v[24:27], v[8:11], v[56:71]
    s_setprio 1
    v_exp_f32 v88, v88
    v_exp_f32 v89, v89
    v_exp_f32 v90, v90
    v_exp_f32 v91, v91
    v_mfma_f32_32x32x16_bf16 v[72:87], v[36:39], v[44:47], v[72:87]
    v_exp_f32 v92, v92
    v_exp_f32 v93, v93
    v_exp_f32 v94, v94
    v_exp_f32 v95, v95
    v_smfmac_f32_16x16x64_bf16 v[52:55], v[48:51], v[40:47], v185
    v_cvt_pk_bf16_f32 v40, v88, v89
    v_cvt_pk_bf16_f32 v41, v90, v91
    v_cvt_pk_bf16_f32 v42, v92, v93
    v_cvt_pk_bf16_f32 v43, v94, v95
    v_mfma_f32_32x32x16_bf16 v[104:119], v[28:31], v[12:15], v[104:119]
    ds_read_b128 v[24:27], v188 offset:24576
    ds_read_b128 v[36:39], v188 offset:19456
    ds_read_b128 v[28:31], v188 offset:25600
    v_exp_f32 v96, v96
    v_exp_f32 v97, v97
    v_exp_f32 v98, v98
    v_exp_f32 v99, v99
    v_mfma_f32_32x32x16_bf16 v[72:87], v[32:35], v[40:43], v[72:87]
    ds_read_b128 v[32:35], v188 offset:22528
    v_cvt_pk_bf16_f32 v44, v96, v97
    v_cvt_pk_bf16_f32 v45, v98, v99
    v_exp_f32 v100, v100
    v_exp_f32 v101, v101
    v_exp_f32 v102, v102
    v_exp_f32 v103, v103
    v_cvt_pk_bf16_f32 v46, v100, v101
    v_cvt_pk_bf16_f32 v47, v102, v103
    s_waitcnt lgkmcnt(0)
    v_mfma_f32_32x32x16_bf16 v[88:103], v[24:27], v[8:11], v[56:71]
    s_setprio 0
    v_exp_f32 v104, v104
    v_exp_f32 v105, v105
    v_exp_f32 v106, v106
    v_exp_f32 v107, v107
    v_mfma_f32_32x32x16_bf16 v[72:87], v[36:39], v[44:47], v[72:87]
    v_exp_f32 v108, v108
    v_exp_f32 v109, v109
    v_exp_f32 v110, v110
    v_exp_f32 v111, v111
    v_smfmac_f32_16x16x64_bf16 v[52:55], v[48:51], v[40:47], v185
    v_cvt_pk_bf16_f32 v40, v104, v105
    v_cvt_pk_bf16_f32 v41, v106, v107
    v_cvt_pk_bf16_f32 v42, v108, v109
    v_cvt_pk_bf16_f32 v43, v110, v111
    v_mfma_f32_32x32x16_bf16 v[88:103], v[28:31], v[12:15], v[88:103]
    ds_read_b128 v[24:27], v188 offset:28672
    ds_read_b128 v[36:39], v188 offset:23552
    ds_read_b128 v[28:31], v188 offset:29696
    v_exp_f32 v112, v112
    v_exp_f32 v113, v113
    v_exp_f32 v114, v114
    v_exp_f32 v115, v115
    v_mfma_f32_32x32x16_bf16 v[72:87], v[32:35], v[40:43], v[72:87]
    ds_read_b128 v[32:35], v188 offset:26624
    v_cvt_pk_bf16_f32 v44, v112, v113
    v_cvt_pk_bf16_f32 v45, v114, v115
    v_exp_f32 v116, v116
    v_exp_f32 v117, v117
    v_exp_f32 v118, v118
    v_exp_f32 v119, v119
    v_cvt_pk_bf16_f32 v46, v116, v117
    v_cvt_pk_bf16_f32 v47, v118, v119
    s_waitcnt lgkmcnt(0)
    v_mfma_f32_32x32x16_bf16 v[104:119], v[24:27], v[8:11], v[56:71]
    s_cmp_lg_u32 s9, 0
    s_cbranch_scc1 L_k2_nw6
    s_waitcnt vmcnt(2)
L_k2_nw6:
    s_barrier
    s_setprio 3
    v_exp_f32 v88, v88
    v_exp_f32 v89, v89
    v_exp_f32 v90, v90
    v_exp_f32 v91, v91
    v_mfma_f32_32x32x16_bf16 v[72:87], v[36:39], v[44:47], v[72:87]
    v_exp_f32 v92, v92
    v_exp_f32 v93, v93
    v_exp_f32 v94, v94
    v_exp_f32 v95, v95
    v_smfmac_f32_16x16x64_bf16 v[52:55], v[48:51], v[40:47], v185
    s_mov_b32 m0, s44
    s_nop 0
    buffer_load_dwordx4 v2, s[16:19], s23 offen sc1 lds
    buffer_load_dwordx4 v2, s[16:19], s23 offen offset:1024 sc1 lds
    s_add_u32 s23, s23, 8192
    v_cvt_pk_bf16_f32 v40, v88, v89
    v_cvt_pk_bf16_f32 v41, v90, v91
    v_cvt_pk_bf16_f32 v42, v92, v93
    v_cvt_pk_bf16_f32 v43, v94, v95
    v_mfma_f32_32x32x16_bf16 v[104:119], v[28:31], v[12:15], v[104:119]
    ds_read_b128 v[24:27], v189 offset:0
    ds_read_b128 v[36:39], v188 offset:27648
    ds_read_b128 v[28:31], v189 offset:1024
    v_exp_f32 v96, v96
    v_exp_f32 v97, v97
    v_exp_f32 v98, v98
    v_exp_f32 v99, v99
    v_mfma_f32_32x32x16_bf16 v[72:87], v[32:35], v[40:43], v[72:87]
    ds_read_b128 v[32:35], v188 offset:30720
    v_cvt_pk_bf16_f32 v44, v96, v97
    v_cvt_pk_bf16_f32 v45, v98, v99
    v_exp_f32 v100, v100
    v_exp_f32 v101, v101
    v_exp_f32 v102, v102
    v_exp_f32 v103, v103
    v_cvt_pk_bf16_f32 v46, v100, v101
    v_cvt_pk_bf16_f32 v47, v102, v103
    s_and_b32 s9, s10, 15
    s_cbranch_scc1 L_k2_hook7
L_k2_hooked7:
    s_lshr_b64 s[10:11], s[10:11], 4
    s_waitcnt lgkmcnt(0)
    v_mfma_f32_32x32x16_bf16 v[88:103], v[24:27], v[8:11], v[56:71]
    s_setprio 2
    v_exp_f32 v104, v104
    v_exp_f32 v105, v105
    v_exp_f32 v106, v106
    v_exp_f32 v107, v107
    v_mfma_f32_32x32x16_bf16 v[72:87], v[36:39], v[44:47], v[72:87]
    v_exp_f32 v108, v108
    v_exp_f32 v109, v109
    v_exp_f32 v110, v110
    v_exp_f32 v111, v111
    v_smfmac_f32_16x16x64_bf16 v[52:55], v[48:51], v[40:47], v185
    v_cvt_pk_bf16_f32 v40, v104, v105
    v_cvt_pk_bf16_f32 v41, v106, v107
    v_cvt_pk_bf16_f32 v42, v108, v109
    v_cvt_pk_bf16_f32 v43, v110, v111
    v_mfma_f32_32x32x16_bf16 v[88:103], v[28:31], v[12:15], v[88:103]
    ds_read_b128 v[24:27], v189 offset:4096
    ds_read_b128 v[36:39], v188 offset:31744
    ds_read_b128 v[28:31], v189 offset:5120
    v_exp_f32 v112, v112
    v_exp_f32 v113, v113
    v_exp_f32 v114, v114
    v_exp_f32 v115, v115
    v_mfma_f32_32x32x16_bf16 v[72:87], v[32:35], v[40:43], v[72:87]
    ds_read_b128 v[32:35], v189 offset:2048
    v_xor_b32 v188, 0x38000, v188
    v_xor_b32 v189, 0x38000, v189
    s_xor_b32 s44, s44, 0x38000
    s_sub_u32 s29, s29, 1
    s_cmp_lg_u32 s29, 0
    v_cvt_pk_bf16_f32 v44, v112, v113
    v_cvt_pk_bf16_f32 v45, v114, v115
    v_exp_f32 v116, v116
    v_exp_f32 v117, v117
    v_exp_f32 v118, v118
    v_exp_f32 v119, v119
    v_cvt_pk_bf16_f32 v46, v116, v117
    v_cvt_pk_bf16_f32 v47, v118, v119
    s_cbranch_scc1 L_k2_loop
    s_branch L_k2_tail
L_k2_hook3:
    s_mov_b32 s45, 0
    s_branch L_j0
L_k2_hook7:
    s_mov_b32 s45, 1
L_j0:
    s_waitcnt vmcnt(2)
    s_cmp_eq_u32 s9, 10
    s_cbranch_scc0 L_j1
    s_mov_b32 m0, s54
    s_add_u32 s54, s54, 16384
    buffer_load_dwordx4 v201, s[36:39], s49 offen offset:0 lds
    buffer_load_dwordx4 v202, s[36:39], s49 offen offset:1024 lds
    buffer_load_dwordx4 v203, s[36:39], s49 offen offset:2048 lds
    buffer_load_dwordx4 v204, s[36:39], s49 offen offset:3072 lds
    s_add_u32 s49, s49, 131072
    s_cmp_ge_u32 s54, 98304
    s_cselect_b32 s4, 98304, 0
    s_sub_u32 s54, s54, s4
L_jret:
    s_cmp_eq_u32 s45, 0
    s_cbranch_scc1 L_k2_hooked3
    s_branch L_k2_hooked7
L_j1:
    s_cmp_eq_u32 s9, 1
    s_cbranch_scc0 L_j2
    s_cmp_eq_u32 s61, 0
    s_cbranch_scc0 L_jret
    v_and_b32 v3, 15, v1
    v_lshrrev_b32 v4, 4, v1
    v_lshlrev_b32 v3, 4, v3
    v_lshl_add_u32 v3, v4, 9, v3
    buffer_store_dwordx4 v[140:143], v3, s[24:27], s100 offen offset:0 sc1
    buffer_store_dwordx4 v[148:151], v3, s[24:27], s100 offen offset:256 sc1
    buffer_store_dwordx4 v[156:159], v3, s[24:27], s100 offen offset:2048 sc1
    buffer_store_dwordx4 v[164:167], v3, s[24:27], s100 offen offset:2304 sc1
    s_branch L_jret
L_j2:
    s_cmp_eq_u32 s9, 2
    s_cbranch_scc0 L_j3
    s_cmp_eq_u32 s61, 0
    s_cbranch_scc0 L_jret
    v_mov_b32 v3, 0
    s_mov_b64 exec, 1
    buffer_store_dword v236, v3, s[24:27], s60 offen offset:0 sc1
    s_mov_b64 exec, -1
    s_branch L_jret
L_j3:
    s_cmp_eq_u32 s9, 3
    s_cbranch_scc0 L_j4
    buffer_load_dword v191, v194, s[24:27], s32 offen sc1
    s_branch L_jret
L_j4:
    s_cmp_eq_u32 s9, 4
    s_cbranch_scc0 L_j5
    s_mov_b32 s55, 262144
    s_branch L_j4w_cmp
L_j4w_chk:
    buffer_load_dword v191, v194, s[24:27], s32 offen sc1
    s_sub_u32 s55, s55, 1
    s_cmp_eq_u32 s55, 0
    s_cbranch_scc1 L_j4w_ok
    s_waitcnt vmcnt(0)
L_j4w_cmp:
    v_cmp_eq_u32 vcc, v236, v191
    s_cmp_eq_u64 vcc, -1
    s_cbranch_scc1 L_j4w_ok
    s_sleep 0
    s_branch L_j4w_chk
L_j4w_ok:
    s_branch L_jret
L_j5:
    s_cmp_eq_u32 s9, 5
    s_cbranch_scc0 L_j6
    buffer_load_dwordx4 v[120:123], v184, s[24:27], s33 offen offset:0 sc1
    buffer_load_dwordx4 v[124:127], v184, s[24:27], s33 offen offset:1024 sc1
    buffer_load_dwordx4 v[128:131], v184, s[24:27], s33 offen offset:2048 sc1
    buffer_load_dwordx4 v[132:135], v184, s[24:27], s33 offen offset:3072 sc1
    buffer_load_dwordx4 v[136:139], v184, s[24:27], s34 offen offset:0 sc1
    buffer_load_dwordx4 v[140:143], v184, s[24:27], s34 offen offset:1024 sc1
    buffer_load_dwordx4 v[144:147], v184, s[24:27], s34 offen offset:2048 sc1
    buffer_load_dwordx4 v[148:151], v184, s[24:27], s34 offen offset:3072 sc1
    buffer_load_dwordx4 v[16:19], v2, s[24:27], s35 offen sc1
    buffer_load_dwordx4 v[20:23], v2, s[24:27], s35 offen offset:1024 sc1
    s_branch L_jret
L_j6:
    s_cmp_eq_u32 s9, 6
    s_cbranch_scc0 L_j7
    v_add_f32 v120, v120, v124
    v_add_f32 v121, v121, v125
    v_add_f32 v122, v122, v126
    v_add_f32 v123, v123, v127
    v_add_f32 v128, v128, v132
    v_add_f32 v129, v129, v133
    v_add_f32 v130, v130, v134
    v_add_f32 v131, v131, v135
    v_add_f32 v136, v136, v140
    v_add_f32 v137, v137, v141
    v_add_f32 v138, v138, v142
    v_add_f32 v139, v139, v143
    v_add_f32 v144, v144, v148
    v_add_f32 v145, v145, v149
    v_add_f32 v146, v146, v150
    v_add_f32 v147, v147, v151
    v_add_f32 v120, v120, v128
    v_add_f32 v121, v121, v129
    v_add_f32 v122, v122, v130
    v_add_f32 v123, v123, v131
    v_add_f32 v136, v136, v144
    v_add_f32 v137, v137, v145
    v_add_f32 v138, v138, v146
    v_add_f32 v139, v139, v147
    v_add_f32 v120, v120, v136
    v_add_f32 v121, v121, v137
    v_add_f32 v122, v122, v138
    v_add_f32 v123, v123, v139
    v_cvt_pk_bf16_f32 v120, v120, v121
    v_cvt_pk_bf16_f32 v121, v122, v123
    ds_write_b64 v186, v[120:121]
    s_branch L_jret
L_j7:
    s_cmp_eq_u32 s9, 8
    s_cbranch_scc0 L_j8
    v_mov_b32 v3, 0
    s_mov_b64 exec, 1
    buffer_store_dword v236, v3, s[24:27], s46 offen offset:0 sc1
    s_mov_b64 exec, -1
    s_branch L_jret
L_j8:
    s_cmp_eq_u32 s9, 9
    s_cbranch_scc0 L_j9
    buffer_load_dword v190, v187, s[36:39], 0 offen
    s_getpc_b64 s[40:41]
L_k2_pc:
    s_mov_b32 s42, L_code_end-L_k2_pc
    s_mov_b32 s43, 0x20000
    s_lshr_b32 s4, s2, 3
    s_lshl_b32 s4, s4, 2
    s_add_u32 s4, s4, s31
    s_lshl_b32 s4, s4, 7
    v_mov_b32 v3, 0
    s_mov_b64 exec, 1
    buffer_load_dword v190, v3, s[40:43], s4 offen
    s_mov_b64 exec, -1
    s_branch L_jret
L_j9:
    v_add_u32 v6, 81920, v2
    ds_read_b128 v[152:155], v6 offset:0
    ds_read_b128 v[156:159], v6 offset:1024
    ds_read_b128 v[160:163], v6 offset:2048
    ds_read_b128 v[164:167], v6 offset:3072
    s_waitcnt lgkmcnt(0)
    v_mfma_f32_32x32x16_bf16 v[136:151], v[160:163], v[16:19], 0
    v_mfma_f32_32x32x16_bf16 v[136:151], v[164:167], v[20:23], v[136:151]
    v_mfma_f32_32x32x16_bf16 v[120:135], v[152:155], v[16:19], 0
    v_mfma_f32_32x32x16_bf16 v[120:135], v[156:159], v[20:23], v[120:135]
    s_nop 9
    v_add_f32 v5, 0x358637bd, v136
    v_rcp_f32 v5, v5
    s_nop 0
    v_mul_f32 v120, v120, v5
    v_mul_f32 v121, v121, v5
    v_mul_f32 v122, v122, v5
    v_mul_f32 v123, v123, v5
    v_mul_f32 v124, v124, v5
    v_mul_f32 v125, v125, v5
    v_mul_f32 v126, v126, v5
    v_mul_f32 v127, v127, v5
    v_mul_f32 v128, v128, v5
    v_mul_f32 v129, v129, v5
    v_mul_f32 v130, v130, v5
    v_mul_f32 v131, v131, v5
    v_mul_f32 v132, v132, v5
    v_mul_f32 v133, v133, v5
    v_mul_f32 v134, v134, v5
    v_mul_f32 v135, v135, v5
    v_cvt_pk_bf16_f32 v120, v120, v121
    v_cvt_pk_bf16_f32 v121, v122, v123
    v_cvt_pk_bf16_f32 v122, v124, v125
    v_cvt_pk_bf16_f32 v123, v126, v127
    v_cvt_pk_bf16_f32 v124, v128, v129
    v_cvt_pk_bf16_f32 v125, v130, v131
    v_cvt_pk_bf16_f32 v126, v132, v133
    v_cvt_pk_bf16_f32 v127, v134, v135
    buffer_store_dwordx4 v[120:123], v2, s[24:27], s30 offen sc1
    buffer_store_dwordx4 v[124:127], v2, s[24:27], s30 offen offset:1024 sc1
    s_branch L_jret
L_k2_tail:
    s_setprio 0
    s_waitcnt lgkmcnt(0)
    v_mfma_f32_32x32x16_bf16 v[72:87], v[36:39], v[44:47], v[72:87]
    v_smfmac_f32_16x16x64_bf16 v[52:55], v[48:51], v[40:47], v185
    v_mov_b32 v120, 0
    v_mov_b32 v121, 0
    v_mov_b32 v122, 0
    v_mov_b32 v123, 0
    v_mov_b32 v124, 0
    v_mov_b32 v125, 0
    v_mov_b32 v126, 0
    v_mov_b32 v127, 0
    v_mov_b32 v128, 0
    v_mov_b32 v129, 0
    v_mov_b32 v130, 0
    v_add_f32 v3, v52, v53
    v_fma_f32 v3, v72, 0, v3
    v_fma_f32 v3, v73, 0, v3
    v_fma_f32 v3, v74, 0, v3
    v_fma_f32 v3, v75, 0, v3
    v_fma_f32 v3, v76, 0, v3
    v_fma_f32 v3, v77, 0, v3
    v_fma_f32 v3, v78, 0, v3
    v_fma_f32 v3, v79, 0, v3
    v_fma_f32 v3, v80, 0, v3
    v_fma_f32 v3, v81, 0, v3
    v_fma_f32 v3, v82, 0, v3
    v_fma_f32 v3, v83, 0, v3
    v_fma_f32 v3, v84, 0, v3
    v_fma_f32 v3, v85, 0, v3
    v_fma_f32 v3, v86, 0, v3
    v_fma_f32 v3, v87, 0, v3
    v_mov_b32 v4, 0x71800000
    v_cmp_nlt_f32 vcc, v3, v4
    v_mov_b32 v131, 0
    v_mov_b32 v132, 0
    v_mov_b32 v133, 0
    v_mov_b32 v134, 0
    v_mov_b32 v135, 0
    s_cbranch_vccnz L_k2_slow
L_k2_fin:
    v_add_f32 v52, v52, v53
    v_mov_b32 v5, v52
    s_nop 1
    v_permlane32_swap_b32 v52, v5
    v_rcp_f32 v5, v52
    s_add_u32 s30, s30, 4194304
    v_mul_f32 v72, v72, v5
    v_mul_f32 v73, v73, v5
    v_mul_f32 v74, v74, v5
    v_mul_f32 v75, v75, v5
    v_mul_f32 v76, v76, v5
    v_mul_f32 v77, v77, v5
    v_mul_f32 v78, v78, v5
    v_mul_f32 v79, v79, v5
    v_mul_f32 v80, v80, v5
    v_mul_f32 v81, v81, v5
    v_mul_f32 v82, v82, v5
    v_mul_f32 v83, v83, v5
    v_mul_f32 v84, v84, v5
    v_mul_f32 v85, v85, v5
    v_mul_f32 v86, v86, v5
    v_mul_f32 v87, v87, v5
    v_cvt_pk_bf16_f32 v72, v72, v73
    v_cvt_pk_bf16_f32 v73, v74, v75
    v_cvt_pk_bf16_f32 v74, v76, v77
    v_cvt_pk_bf16_f32 v75, v78, v79
    v_cvt_pk_bf16_f32 v76, v80, v81
    v_cvt_pk_bf16_f32 v77, v82, v83
    v_cvt_pk_bf16_f32 v78, v84, v85
    v_cvt_pk_bf16_f32 v79, v86, v87
    buffer_store_dwordx4 v[72:75], v2, s[24:27], s30 offen sc1
    buffer_store_dwordx4 v[76:79], v2, s[24:27], s30 offen offset:1024 sc1
    s_cmp_ge_u32 s31, 4
    s_cbranch_scc1 L_k3_prod
    v_mov_b32 v136, 0
    v_mov_b32 v137, 0
    v_mov_b32 v138, 0
    v_mov_b32 v139, 0
    v_mov_b32 v140, 0
    v_mov_b32 v141, 0
    v_mov_b32 v142, 0
    v_mov_b32 v143, 0
    v_mov_b32 v144, 0
    v_mov_b32 v145, 0
    v_mov_b32 v146, 0
    v_mov_b32 v147, 0
    v_mov_b32 v148, 0
    v_mov_b32 v149, 0
    v_mov_b32 v150, 0
    v_mov_b32 v151, 0
    v_mov_b32 v152, 0
    v_mov_b32 v153, 0
    v_mov_b32 v154, 0
    v_mov_b32 v155, 0
    v_mov_b32 v156, 0
    v_mov_b32 v157, 0
    v_mov_b32 v158, 0
    v_mov_b32 v159, 0
    v_mov_b32 v160, 0
    v_mov_b32 v161, 0
    v_mov_b32 v162, 0
    v_mov_b32 v163, 0
    v_mov_b32 v164, 0
    v_mov_b32 v165, 0
    v_mov_b32 v166, 0
    v_mov_b32 v167, 0
    v_mov_b32 v168, 0
    v_mov_b32 v169, 0
    v_mov_b32 v170, 0
    v_mov_b32 v171, 0
    v_mov_b32 v172, 0
    v_mov_b32 v173, 0
    v_mov_b32 v174, 0
    v_mov_b32 v175, 0
    v_mov_b32 v176, 0
    v_mov_b32 v177, 0
    v_mov_b32 v178, 0
    v_mov_b32 v179, 0
    v_mov_b32 v180, 0
    v_mov_b32 v181, 0
    v_mov_b32 v182, 0
    v_mov_b32 v183, 0
    s_mov_b32 s52, 4
    s_mov_b32 s5, 0
    s_mov_b32 s6, 0xffff0000
    s_mov_b32 s7, 32768
    s_waitcnt vmcnt(0)
    s_barrier
    s_cmp_eq_u32 s31, 0
    s_cbranch_scc0 L_k3_c1
    s_add_u32 s46, s46, 32768
    v_mov_b32 v3, 0
    s_mov_b64 exec, 1
    buffer_store_dword v236, v3, s[24:27], s46 offen offset:0 sc1
    s_mov_b64 exec, -1
    s_mov_b32 s55, 262144
L_k3_w_chk:
    buffer_load_dword v191, v192, s[24:27], s47 offen sc1
    s_sub_u32 s55, s55, 1
    s_cmp_eq_u32 s55, 0
    s_cbranch_scc1 L_k3_w_ok
    s_waitcnt vmcnt(0)
L_k3_w_cmp:
    v_cmp_eq_u32 vcc, v236, v191
    s_cmp_eq_u64 vcc, -1
    s_cbranch_scc1 L_k3_w_ok
    s_sleep 0
    s_branch L_k3_w_chk
L_k3_w_ok:
L_k3_c1:
    s_barrier
    s_barrier
    ds_read_b128 v[56:59], v196 offset:0
    ds_read_b64_tr_b16 v[88:89], v197 offset:0
    ds_read_b64_tr_b16 v[90:91], v197 offset:2048
    ds_read_b64_tr_b16 v[92:93], v198 offset:0
    ds_read_b64_tr_b16 v[94:95], v198 offset:2048
    ds_read_b128 v[60:63], v196 offset:256
    ds_read_b64_tr_b16 v[96:97], v199 offset:0
    ds_read_b64_tr_b16 v[98:99], v199 offset:2048
    ds_read_b64_tr_b16 v[100:101], v200 offset:0
    ds_read_b64_tr_b16 v[102:103], v200 offset:2048
    ds_read_b128 v[64:67], v196 offset:4096
    ds_read_b128 v[68:71], v196 offset:4352
.p2align 6
L_k3_loop:
    s_waitcnt lgkmcnt(9)
    v_mfma_f32_16x16x32_bf16 v[120:123], v[88:91], v[56:59], v[120:123]
    ds_read_b128 v[104:107], v196 offset:2048
    s_waitcnt lgkmcnt(8)
    v_mfma_f32_16x16x32_bf16 v[124:127], v[92:95], v[56:59], v[124:127]
    ds_read_b64_tr_b16 v[8:9], v197 offset:8192
    s_waitcnt lgkmcnt(8)
    v_mfma_f32_16x16x32_bf16 v[140:143], v[92:95], v[60:63], v[140:143]
    ds_read_b64_tr_b16 v[10:11], v197 offset:10240
    v_mfma_f32_16x16x32_bf16 v[136:139], v[88:91], v[60:63], v[136:139]
    ds_read_b64_tr_b16 v[12:13], v198 offset:8192
    s_waitcnt lgkmcnt(8)
    v_mfma_f32_16x16x32_bf16 v[144:147], v[96:99], v[60:63], v[144:147]
    ds_read_b64_tr_b16 v[14:15], v198 offset:10240
    v_mfma_f32_16x16x32_bf16 v[128:131], v[96:99], v[56:59], v[128:131]
    ds_read_b128 v[108:111], v196 offset:2304
    s_waitcnt lgkmcnt(8)
    v_mfma_f32_16x16x32_bf16 v[132:135], v[100:103], v[56:59], v[132:135]
    ds_read_b64_tr_b16 v[16:17], v199 offset:8192
    v_mfma_f32_16x16x32_bf16 v[148:151], v[100:103], v[60:63], v[148:151]
    ds_read_b64_tr_b16 v[18:19], v199 offset:10240
    s_waitcnt lgkmcnt(9)
    v_mfma_f32_16x16x32_bf16 v[164:167], v[100:103], v[64:67], v[164:167]
    ds_read_b64_tr_b16 v[20:21], v200 offset:8192
    v_mfma_f32_16x16x32_bf16 v[160:163], v[96:99], v[64:67], v[160:163]
    ds_read_b64_tr_b16 v[22:23], v200 offset:10240
    v_mfma_f32_16x16x32_bf16 v[156:159], v[92:95], v[64:67], v[156:159]
    ds_read_b128 v[112:115], v196 offset:6144
    v_mfma_f32_16x16x32_bf16 v[152:155], v[88:91], v[64:67], v[152:155]
    ds_read_b128 v[116:119], v196 offset:6400
    s_waitcnt lgkmcnt(12)
    v_mfma_f32_16x16x32_bf16 v[168:171], v[88:91], v[68:71], v[168:171]
    v_mfma_f32_16x16x32_bf16 v[172:175], v[92:95], v[68:71], v[172:175]
    v_mfma_f32_16x16x32_bf16 v[176:179], v[96:99], v[68:71], v[176:179]
    v_mfma_f32_16x16x32_bf16 v[180:183], v[100:103], v[68:71], v[180:183]
    s_waitcnt lgkmcnt(9)
    v_mfma_f32_16x16x32_bf16 v[120:123], v[8:11], v[104:107], v[120:123]
    s_waitcnt lgkmcnt(7)
    v_mfma_f32_16x16x32_bf16 v[124:127], v[12:15], v[104:107], v[124:127]
    s_waitcnt lgkmcnt(6)
    v_mfma_f32_16x16x32_bf16 v[140:143], v[12:15], v[108:111], v[140:143]
    v_mfma_f32_16x16x32_bf16 v[136:139], v[8:11], v[108:111], v[136:139]
    s_waitcnt lgkmcnt(0)
    s_barrier
    ds_read_b128 v[56:59], v196 offset:16384
    v_mfma_f32_16x16x32_bf16 v[144:147], v[16:19], v[108:111], v[144:147]
    ds_read_b64_tr_b16 v[88:89], v197 offset:16384
    v_mfma_f32_16x16x32_bf16 v[128:131], v[16:19], v[104:107], v[128:131]
    ds_read_b64_tr_b16 v[90:91], v197 offset:18432
    v_mfma_f32_16x16x32_bf16 v[132:135], v[20:23], v[104:107], v[132:135]
    ds_read_b64_tr_b16 v[92:93], v198 offset:16384
    v_mfma_f32_16x16x32_bf16 v[148:151], v[20:23], v[108:111], v[148:151]
    ds_read_b64_tr_b16 v[94:95], v198 offset:18432
    v_mfma_f32_16x16x32_bf16 v[164:167], v[20:23], v[112:115], v[164:167]
    ds_read_b128 v[60:63], v196 offset:16640
    v_mfma_f32_16x16x32_bf16 v[160:163], v[16:19], v[112:115], v[160:163]
    ds_read_b64_tr_b16 v[96:97], v199 offset:16384
    v_mfma_f32_16x16x32_bf16 v[156:159], v[12:15], v[112:115], v[156:159]
    ds_read_b64_tr_b16 v[98:99], v199 offset:18432
    v_mfma_f32_16x16x32_bf16 v[152:155], v[8:11], v[112:115], v[152:155]
    ds_read_b64_tr_b16 v[100:101], v200 offset:16384
    v_mfma_f32_16x16x32_bf16 v[168:171], v[8:11], v[116:119], v[168:171]
    ds_read_b64_tr_b16 v[102:103], v200 offset:18432
    v_mfma_f32_16x16x32_bf16 v[172:175], v[12:15], v[116:119], v[172:175]
    ds_read_b128 v[64:67], v196 offset:20480
    v_mfma_f32_16x16x32_bf16 v[176:179], v[16:19], v[116:119], v[176:179]
    ds_read_b128 v[68:71], v196 offset:20736
    v_mfma_f32_16x16x32_bf16 v[180:183], v[20:23], v[116:119], v[180:183]
    s_waitcnt lgkmcnt(9)
    v_mfma_f32_16x16x32_bf16 v[120:123], v[88:91], v[56:59], v[120:123]
    ds_read_b128 v[104:107], v196 offset:18432
    s_waitcnt lgkmcnt(8)
    v_mfma_f32_16x16x32_bf16 v[124:127], v[92:95], v[56:59], v[124:127]
    ds_read_b64_tr_b16 v[8:9], v197 offset:24576
    s_waitcnt lgkmcnt(8)
    v_mfma_f32_16x16x32_bf16 v[140:143], v[92:95], v[60:63], v[140:143]
    ds_read_b64_tr_b16 v[10:11], v197 offset:26624
    v_mfma_f32_16x16x32_bf16 v[136:139], v[88:91], v[60:63], v[136:139]
    ds_read_b64_tr_b16 v[12:13], v198 offset:24576
    s_waitcnt lgkmcnt(8)
    v_mfma_f32_16x16x32_bf16 v[144:147], v[96:99], v[60:63], v[144:147]
    ds_read_b64_tr_b16 v[14:15], v198 offset:26624
    v_mfma_f32_16x16x32_bf16 v[128:131], v[96:99], v[56:59], v[128:131]
    ds_read_b128 v[108:111], v196 offset:18688
    s_waitcnt lgkmcnt(8)
    v_mfma_f32_16x16x32_bf16 v[132:135], v[100:103], v[56:59], v[132:135]
    ds_read_b64_tr_b16 v[16:17], v199 offset:24576
    v_mfma_f32_16x16x32_bf16 v[148:151], v[100:103], v[60:63], v[148:151]
    ds_read_b64_tr_b16 v[18:19], v199 offset:26624
    s_waitcnt lgkmcnt(9)
    v_mfma_f32_16x16x32_bf16 v[164:167], v[100:103], v[64:67], v[164:167]
    ds_read_b64_tr_b16 v[20:21], v200 offset:24576
    v_mfma_f32_16x16x32_bf16 v[160:163], v[96:99], v[64:67], v[160:163]
    ds_read_b64_tr_b16 v[22:23], v200 offset:26624
    v_mfma_f32_16x16x32_bf16 v[156:159], v[92:95], v[64:67], v[156:159]
    ds_read_b128 v[112:115], v196 offset:22528
    v_mfma_f32_16x16x32_bf16 v[152:155], v[88:91], v[64:67], v[152:155]
    ds_read_b128 v[116:119], v196 offset:22784
    s_waitcnt lgkmcnt(12)
    v_mfma_f32_16x16x32_bf16 v[168:171], v[88:91], v[68:71], v[168:171]
    s_add_u32 s5, s5, 1
    s_cmp_eq_u32 s5, 3
    v_mfma_f32_16x16x32_bf16 v[172:175], v[92:95], v[68:71], v[172:175]
    s_cselect_b32 s5, 0, s5
    s_cselect_b32 s4, s6, s7
    v_mfma_f32_16x16x32_bf16 v[176:179], v[96:99], v[68:71], v[176:179]
    v_add_u32 v197, s4, v197
    v_add_u32 v198, s4, v198
    v_mfma_f32_16x16x32_bf16 v[180:183], v[100:103], v[68:71], v[180:183]
    v_add_u32 v199, s4, v199
    v_add_u32 v200, s4, v200
    s_waitcnt lgkmcnt(9)
    v_mfma_f32_16x16x32_bf16 v[120:123], v[8:11], v[104:107], v[120:123]
    s_waitcnt lgkmcnt(7)
    v_mfma_f32_16x16x32_bf16 v[124:127], v[12:15], v[104:107], v[124:127]
    s_waitcnt lgkmcnt(6)
    v_mfma_f32_16x16x32_bf16 v[140:143], v[12:15], v[108:111], v[140:143]
    v_mfma_f32_16x16x32_bf16 v[136:139], v[8:11], v[108:111], v[136:139]
    s_waitcnt lgkmcnt(0)
    s_barrier
    ds_read_b128 v[56:59], v196 offset:32768
    v_mfma_f32_16x16x32_bf16 v[144:147], v[16:19], v[108:111], v[144:147]
    ds_read_b64_tr_b16 v[88:89], v197 offset:0
    v_mfma_f32_16x16x32_bf16 v[128:131], v[16:19], v[104:107], v[128:131]
    ds_read_b64_tr_b16 v[90:91], v197 offset:2048
    v_mfma_f32_16x16x32_bf16 v[132:135], v[20:23], v[104:107], v[132:135]
    ds_read_b64_tr_b16 v[92:93], v198 offset:0
    v_mfma_f32_16x16x32_bf16 v[148:151], v[20:23], v[108:111], v[148:151]
    ds_read_b64_tr_b16 v[94:95], v198 offset:2048
    v_mfma_f32_16x16x32_bf16 v[164:167], v[20:23], v[112:115], v[164:167]
    ds_read_b128 v[60:63], v196 offset:33024
    v_mfma_f32_16x16x32_bf16 v[160:163], v[16:19], v[112:115], v[160:163]
    ds_read_b64_tr_b16 v[96:97], v199 offset:0
    v_mfma_f32_16x16x32_bf16 v[156:159], v[12:15], v[112:115], v[156:159]
    ds_read_b64_tr_b16 v[98:99], v199 offset:2048
    v_mfma_f32_16x16x32_bf16 v[152:155], v[8:11], v[112:115], v[152:155]
    ds_read_b64_tr_b16 v[100:101], v200 offset:0
    v_mfma_f32_16x16x32_bf16 v[168:171], v[8:11], v[116:119], v[168:171]
    ds_read_b64_tr_b16 v[102:103], v200 offset:2048
    v_mfma_f32_16x16x32_bf16 v[172:175], v[12:15], v[116:119], v[172:175]
    ds_read_b128 v[64:67], v196 offset:36864
    v_mfma_f32_16x16x32_bf16 v[176:179], v[16:19], v[116:119], v[176:179]
    ds_read_b128 v[68:71], v196 offset:37120
    v_mfma_f32_16x16x32_bf16 v[180:183], v[20:23], v[116:119], v[180:183]
    s_waitcnt lgkmcnt(9)
    v_mfma_f32_16x16x32_bf16 v[120:123], v[88:91], v[56:59], v[120:123]
    ds_read_b128 v[104:107], v196 offset:34816
    s_waitcnt lgkmcnt(8)
    v_mfma_f32_16x16x32_bf16 v[124:127], v[92:95], v[56:59], v[124:127]
    ds_read_b64_tr_b16 v[8:9], v197 offset:8192
    s_waitcnt lgkmcnt(8)
    v_mfma_f32_16x16x32_bf16 v[140:143], v[92:95], v[60:63], v[140:143]
    ds_read_b64_tr_b16 v[10:11], v197 offset:10240
    v_mfma_f32_16x16x32_bf16 v[136:139], v[88:91], v[60:63], v[136:139]
    ds_read_b64_tr_b16 v[12:13], v198 offset:8192
    s_waitcnt lgkmcnt(8)
    v_mfma_f32_16x16x32_bf16 v[144:147], v[96:99], v[60:63], v[144:147]
    ds_read_b64_tr_b16 v[14:15], v198 offset:10240
    v_mfma_f32_16x16x32_bf16 v[128:131], v[96:99], v[56:59], v[128:131]
    ds_read_b128 v[108:111], v196 offset:35072
    s_waitcnt lgkmcnt(8)
    v_mfma_f32_16x16x32_bf16 v[132:135], v[100:103], v[56:59], v[132:135]
    ds_read_b64_tr_b16 v[16:17], v199 offset:8192
    v_mfma_f32_16x16x32_bf16 v[148:151], v[100:103], v[60:63], v[148:151]
    ds_read_b64_tr_b16 v[18:19], v199 offset:10240
    s_waitcnt lgkmcnt(9)
    v_mfma_f32_16x16x32_bf16 v[164:167], v[100:103], v[64:67], v[164:167]
    ds_read_b64_tr_b16 v[20:21], v200 offset:8192
    v_mfma_f32_16x16x32_bf16 v[160:163], v[96:99], v[64:67], v[160:163]
    ds_read_b64_tr_b16 v[22:23], v200 offset:10240
    v_mfma_f32_16x16x32_bf16 v[156:159], v[92:95], v[64:67], v[156:159]
    ds_read_b128 v[112:115], v196 offset:38912
    v_mfma_f32_16x16x32_bf16 v[152:155], v[88:91], v[64:67], v[152:155]
    ds_read_b128 v[116:119], v196 offset:39168
    s_waitcnt lgkmcnt(12)
    v_mfma_f32_16x16x32_bf16 v[168:171], v[88:91], v[68:71], v[168:171]
    s_sub_u32 s52, s52, 1
    v_mfma_f32_16x16x32_bf16 v[172:175], v[92:95], v[68:71], v[172:175]
    v_mfma_f32_16x16x32_bf16 v[176:179], v[96:99], v[68:71], v[176:179]
    v_mfma_f32_16x16x32_bf16 v[180:183], v[100:103], v[68:71], v[180:183]
    s_waitcnt lgkmcnt(9)
    v_mfma_f32_16x16x32_bf16 v[120:123], v[8:11], v[104:107], v[120:123]
    s_waitcnt lgkmcnt(7)
    v_mfma_f32_16x16x32_bf16 v[124:127], v[12:15], v[104:107], v[124:127]
    s_waitcnt lgkmcnt(6)
    v_mfma_f32_16x16x32_bf16 v[140:143], v[12:15], v[108:111], v[140:143]
    v_mfma_f32_16x16x32_bf16 v[136:139], v[8:11], v[108:111], v[136:139]
    s_waitcnt lgkmcnt(0)
    s_barrier
    ds_read_b128 v[56:59], v196 offset:49152
    v_mfma_f32_16x16x32_bf16 v[144:147], v[16:19], v[108:111], v[144:147]
    ds_read_b64_tr_b16 v[88:89], v197 offset:16384
    v_mfma_f32_16x16x32_bf16 v[128:131], v[16:19], v[104:107], v[128:131]
    ds_read_b64_tr_b16 v[90:91], v197 offset:18432
    v_mfma_f32_16x16x32_bf16 v[132:135], v[20:23], v[104:107], v[132:135]
    ds_read_b64_tr_b16 v[92:93], v198 offset:16384
    v_mfma_f32_16x16x32_bf16 v[148:151], v[20:23], v[108:111], v[148:151]
    ds_read_b64_tr_b16 v[94:95], v198 offset:18432
    v_mfma_f32_16x16x32_bf16 v[164:167], v[20:23], v[112:115], v[164:167]
    ds_read_b128 v[60:63], v196 offset:49408
    v_mfma_f32_16x16x32_bf16 v[160:163], v[16:19], v[112:115], v[160:163]
    ds_read_b64_tr_b16 v[96:97], v199 offset:16384
    v_mfma_f32_16x16x32_bf16 v[156:159], v[12:15], v[112:115], v[156:159]
    ds_read_b64_tr_b16 v[98:99], v199 offset:18432
    v_mfma_f32_16x16x32_bf16 v[152:155], v[8:11], v[112:115], v[152:155]
    ds_read_b64_tr_b16 v[100:101], v200 offset:16384
    v_mfma_f32_16x16x32_bf16 v[168:171], v[8:11], v[116:119], v[168:171]
    ds_read_b64_tr_b16 v[102:103], v200 offset:18432
    v_mfma_f32_16x16x32_bf16 v[172:175], v[12:15], v[116:119], v[172:175]
    ds_read_b128 v[64:67], v196 offset:53248
    v_mfma_f32_16x16x32_bf16 v[176:179], v[16:19], v[116:119], v[176:179]
    ds_read_b128 v[68:71], v196 offset:53504
    v_mfma_f32_16x16x32_bf16 v[180:183], v[20:23], v[116:119], v[180:183]
    s_waitcnt lgkmcnt(9)
    v_mfma_f32_16x16x32_bf16 v[120:123], v[88:91], v[56:59], v[120:123]
    ds_read_b128 v[104:107], v196 offset:51200
    s_waitcnt lgkmcnt(8)
    v_mfma_f32_16x16x32_bf16 v[124:127], v[92:95], v[56:59], v[124:127]
    ds_read_b64_tr_b16 v[8:9], v197 offset:24576
    s_waitcnt lgkmcnt(8)
    v_mfma_f32_16x16x32_bf16 v[140:143], v[92:95], v[60:63], v[140:143]
    ds_read_b64_tr_b16 v[10:11], v197 offset:26624
    v_mfma_f32_16x16x32_bf16 v[136:139], v[88:91], v[60:63], v[136:139]
    ds_read_b64_tr_b16 v[12:13], v198 offset:24576
    s_waitcnt lgkmcnt(8)
    v_mfma_f32_16x16x32_bf16 v[144:147], v[96:99], v[60:63], v[144:147]
    ds_read_b64_tr_b16 v[14:15], v198 offset:26624
    v_mfma_f32_16x16x32_bf16 v[128:131], v[96:99], v[56:59], v[128:131]
    ds_read_b128 v[108:111], v196 offset:51456
    s_waitcnt lgkmcnt(8)
    v_mfma_f32_16x16x32_bf16 v[132:135], v[100:103], v[56:59], v[132:135]
    ds_read_b64_tr_b16 v[16:17], v199 offset:24576
    v_mfma_f32_16x16x32_bf16 v[148:151], v[100:103], v[60:63], v[148:151]
    ds_read_b64_tr_b16 v[18:19], v199 offset:26624
    s_waitcnt lgkmcnt(9)
    v_mfma_f32_16x16x32_bf16 v[164:167], v[100:103], v[64:67], v[164:167]
    ds_read_b64_tr_b16 v[20:21], v200 offset:24576
    v_mfma_f32_16x16x32_bf16 v[160:163], v[96:99], v[64:67], v[160:163]
    ds_read_b64_tr_b16 v[22:23], v200 offset:26624
    v_mfma_f32_16x16x32_bf16 v[156:159], v[92:95], v[64:67], v[156:159]
    ds_read_b128 v[112:115], v196 offset:55296
    v_mfma_f32_16x16x32_bf16 v[152:155], v[88:91], v[64:67], v[152:155]
    ds_read_b128 v[116:119], v196 offset:55552
    s_waitcnt lgkmcnt(12)
    v_mfma_f32_16x16x32_bf16 v[168:171], v[88:91], v[68:71], v[168:171]
    s_add_u32 s5, s5, 1
    s_cmp_eq_u32 s5, 3
    v_mfma_f32_16x16x32_bf16 v[172:175], v[92:95], v[68:71], v[172:175]
    s_cselect_b32 s5, 0, s5
    s_cselect_b32 s4, s6, s7
    v_mfma_f32_16x16x32_bf16 v[176:179], v[96:99], v[68:71], v[176:179]
    v_add_u32 v197, s4, v197
    v_add_u32 v198, s4, v198
    v_mfma_f32_16x16x32_bf16 v[180:183], v[100:103], v[68:71], v[180:183]
    v_add_u32 v199, s4, v199
    v_add_u32 v200, s4, v200
    s_cmp_eq_u32 s52, 0
    s_cbranch_scc1 L_k3_last
    s_waitcnt lgkmcnt(9)
    v_mfma_f32_16x16x32_bf16 v[120:123], v[8:11], v[104:107], v[120:123]
    s_waitcnt lgkmcnt(7)
    v_mfma_f32_16x16x32_bf16 v[124:127], v[12:15], v[104:107], v[124:127]
    s_waitcnt lgkmcnt(6)
    v_mfma_f32_16x16x32_bf16 v[140:143], v[12:15], v[108:111], v[140:143]
    v_mfma_f32_16x16x32_bf16 v[136:139], v[8:11], v[108:111], v[136:139]
    s_waitcnt lgkmcnt(0)
    s_barrier
    ds_read_b128 v[56:59], v196 offset:0
    v_mfma_f32_16x16x32_bf16 v[144:147], v[16:19], v[108:111], v[144:147]
    ds_read_b64_tr_b16 v[88:89], v197 offset:0
    v_mfma_f32_16x16x32_bf16 v[128:131], v[16:19], v[104:107], v[128:131]
    ds_read_b64_tr_b16 v[90:91], v197 offset:2048
    v_mfma_f32_16x16x32_bf16 v[132:135], v[20:23], v[104:107], v[132:135]
    ds_read_b64_tr_b16 v[92:93], v198 offset:0
    v_mfma_f32_16x16x32_bf16 v[148:151], v[20:23], v[108:111], v[148:151]
    ds_read_b64_tr_b16 v[94:95], v198 offset:2048
    v_mfma_f32_16x16x32_bf16 v[164:167], v[20:23], v[112:115], v[164:167]
    ds_read_b128 v[60:63], v196 offset:256
    v_mfma_f32_16x16x32_bf16 v[160:163], v[16:19], v[112:115], v[160:163]
    ds_read_b64_tr_b16 v[96:97], v199 offset:0
    v_mfma_f32_16x16x32_bf16 v[156:159], v[12:15], v[112:115], v[156:159]
    ds_read_b64_tr_b16 v[98:99], v199 offset:2048
    v_mfma_f32_16x16x32_bf16 v[152:155], v[8:11], v[112:115], v[152:155]
    ds_read_b64_tr_b16 v[100:101], v200 offset:0
    v_mfma_f32_16x16x32_bf16 v[168:171], v[8:11], v[116:119], v[168:171]
    ds_read_b64_tr_b16 v[102:103], v200 offset:2048
    v_mfma_f32_16x16x32_bf16 v[172:175], v[12:15], v[116:119], v[172:175]
    ds_read_b128 v[64:67], v196 offset:4096
    v_mfma_f32_16x16x32_bf16 v[176:179], v[16:19], v[116:119], v[176:179]
    ds_read_b128 v[68:71], v196 offset:4352
    v_mfma_f32_16x16x32_bf16 v[180:183], v[20:23], v[116:119], v[180:183]
    s_branch L_k3_loop
L_k3_last:
    s_waitcnt lgkmcnt(9)
    v_mfma_f32_16x16x32_bf16 v[120:123], v[8:11], v[104:107], v[120:123]
    s_waitcnt lgkmcnt(7)
    v_mfma_f32_16x16x32_bf16 v[124:127], v[12:15], v[104:107], v[124:127]
    s_waitcnt lgkmcnt(6)
    v_mfma_f32_16x16x32_bf16 v[140:143], v[12:15], v[108:111], v[140:143]
    v_mfma_f32_16x16x32_bf16 v[136:139], v[8:11], v[108:111], v[136:139]
    s_waitcnt lgkmcnt(4)
    v_mfma_f32_16x16x32_bf16 v[144:147], v[16:19], v[108:111], v[144:147]
    v_mfma_f32_16x16x32_bf16 v[128:131], v[16:19], v[104:107], v[128:131]
    s_waitcnt lgkmcnt(2)
    v_mfma_f32_16x16x32_bf16 v[132:135], v[20:23], v[104:107], v[132:135]
    v_mfma_f32_16x16x32_bf16 v[148:151], v[20:23], v[108:111], v[148:151]
    s_waitcnt lgkmcnt(1)
    v_mfma_f32_16x16x32_bf16 v[164:167], v[20:23], v[112:115], v[164:167]
    v_mfma_f32_16x16x32_bf16 v[160:163], v[16:19], v[112:115], v[160:163]
    v_mfma_f32_16x16x32_bf16 v[156:159], v[12:15], v[112:115], v[156:159]
    v_mfma_f32_16x16x32_bf16 v[152:155], v[8:11], v[112:115], v[152:155]
    s_waitcnt lgkmcnt(0)
    v_mfma_f32_16x16x32_bf16 v[168:171], v[8:11], v[116:119], v[168:171]
    v_mfma_f32_16x16x32_bf16 v[172:175], v[12:15], v[116:119], v[172:175]
    v_mfma_f32_16x16x32_bf16 v[176:179], v[16:19], v[116:119], v[176:179]
    v_mfma_f32_16x16x32_bf16 v[180:183], v[20:23], v[116:119], v[180:183]
    v_cvt_pk_bf16_f32 v120, v120, v121
    v_cvt_pk_bf16_f32 v121, v122, v123
    v_cvt_pk_bf16_f32 v122, v124, v125
    v_cvt_pk_bf16_f32 v123, v126, v127
    v_cvt_pk_bf16_f32 v128, v128, v129
    v_cvt_pk_bf16_f32 v129, v130, v131
    v_cvt_pk_bf16_f32 v130, v132, v133
    v_cvt_pk_bf16_f32 v131, v134, v135
    v_permlane16_swap_b32 v120, v122
    v_permlane16_swap_b32 v121, v123
    buffer_store_dwordx4 v[120:123], v193, s[56:59], s53 offen offset:0 sc1 nt
    s_nop 0
    v_permlane16_swap_b32 v128, v130
    v_permlane16_swap_b32 v129, v131
    buffer_store_dwordx4 v[128:131], v193, s[56:59], s53 offen offset:64 sc1 nt
    s_add_u32 s53, s53, 65536
    v_cvt_pk_bf16_f32 v136, v136, v137
    v_cvt_pk_bf16_f32 v137, v138, v139
    v_cvt_pk_bf16_f32 v138, v140, v141
    v_cvt_pk_bf16_f32 v139, v142, v143
    v_cvt_pk_bf16_f32 v144, v144, v145
    v_cvt_pk_bf16_f32 v145, v146, v147
    v_cvt_pk_bf16_f32 v146, v148, v149
    v_cvt_pk_bf16_f32 v147, v150, v151
    v_permlane16_swap_b32 v136, v138
    v_permlane16_swap_b32 v137, v139
    buffer_store_dwordx4 v[136:139], v193, s[56:59], s53 offen offset:0 sc1 nt
    s_nop 0
    v_permlane16_swap_b32 v144, v146
    v_permlane16_swap_b32 v145, v147
    buffer_store_dwordx4 v[144:147], v193, s[56:59], s53 offen offset:64 sc1 nt
    s_add_u32 s53, s53, 65536
    v_cvt_pk_bf16_f32 v152, v152, v153
    v_cvt_pk_bf16_f32 v153, v154, v155
    v_cvt_pk_bf16_f32 v154, v156, v157
    v_cvt_pk_bf16_f32 v155, v158, v159
    v_cvt_pk_bf16_f32 v160, v160, v161
    v_cvt_pk_bf16_f32 v161, v162, v163
    v_cvt_pk_bf16_f32 v162, v164, v165
    v_cvt_pk_bf16_f32 v163, v166, v167
    v_permlane16_swap_b32 v152, v154
    v_permlane16_swap_b32 v153, v155
    buffer_store_dwordx4 v[152:155], v193, s[56:59], s53 offen offset:0 sc1 nt
    s_nop 0
    v_permlane16_swap_b32 v160, v162
    v_permlane16_swap_b32 v161, v163
    buffer_store_dwordx4 v[160:163], v193, s[56:59], s53 offen offset:64 sc1 nt
    s_add_u32 s53, s53, 65536
    v_cvt_pk_bf16_f32 v168, v168, v169
    v_cvt_pk_bf16_f32 v169, v170, v171
    v_cvt_pk_bf16_f32 v170, v172, v173
    v_cvt_pk_bf16_f32 v171, v174, v175
    v_cvt_pk_bf16_f32 v176, v176, v177
    v_cvt_pk_bf16_f32 v177, v178, v179
    v_cvt_pk_bf16_f32 v178, v180, v181
    v_cvt_pk_bf16_f32 v179, v182, v183
    v_permlane16_swap_b32 v168, v170
    v_permlane16_swap_b32 v169, v171
    buffer_store_dwordx4 v[168:171], v193, s[56:59], s53 offen offset:0 sc1 nt
    s_nop 0
    v_permlane16_swap_b32 v176, v178
    v_permlane16_swap_b32 v177, v179
    buffer_store_dwordx4 v[176:179], v193, s[56:59], s53 offen offset:64 sc1 nt
L_end:
    s_endpgm
L_k3_prod:
    s_waitcnt vmcnt(0)
    s_barrier
    s_mov_b32 m0, s54
    s_add_u32 s54, s54, 16384
    buffer_load_dwordx4 v201, s[36:39], s49 offen offset:0 lds
    buffer_load_dwordx4 v202, s[36:39], s49 offen offset:1024 lds
    buffer_load_dwordx4 v203, s[36:39], s49 offen offset:2048 lds
    buffer_load_dwordx4 v204, s[36:39], s49 offen offset:3072 lds
    s_add_u32 s49, s49, 131072
    s_cmp_ge_u32 s54, 98304
    s_cselect_b32 s4, 98304, 0
    s_sub_u32 s54, s54, s4
    s_mov_b32 m0, s54
    s_add_u32 s54, s54, 16384
    buffer_load_dwordx4 v201, s[36:39], s49 offen offset:0 lds
    buffer_load_dwordx4 v202, s[36:39], s49 offen offset:1024 lds
    buffer_load_dwordx4 v203, s[36:39], s49 offen offset:2048 lds
    buffer_load_dwordx4 v204, s[36:39], s49 offen offset:3072 lds
    s_add_u32 s49, s49, 131072
    s_cmp_ge_u32 s54, 98304
    s_cselect_b32 s4, 98304, 0
    s_sub_u32 s54, s54, s4
    s_mov_b32 m0, s54
    s_add_u32 s54, s54, 16384
    buffer_load_dwordx4 v201, s[36:39], s49 offen offset:0 lds
    buffer_load_dwordx4 v202, s[36:39], s49 offen offset:1024 lds
    buffer_load_dwordx4 v203, s[36:39], s49 offen offset:2048 lds
    buffer_load_dwordx4 v204, s[36:39], s49 offen offset:3072 lds
    s_add_u32 s49, s49, 131072
    s_cmp_ge_u32 s54, 98304
    s_cselect_b32 s4, 98304, 0
    s_sub_u32 s54, s54, s4
    s_mov_b32 m0, s54
    s_add_u32 s54, s54, 16384
    buffer_load_dwordx4 v201, s[36:39], s49 offen offset:0 lds
    buffer_load_dwordx4 v202, s[36:39], s49 offen offset:1024 lds
    buffer_load_dwordx4 v203, s[36:39], s49 offen offset:2048 lds
    buffer_load_dwordx4 v204, s[36:39], s49 offen offset:3072 lds
    s_add_u32 s49, s49, 131072
    s_cmp_ge_u32 s54, 98304
    s_cselect_b32 s4, 98304, 0
    s_sub_u32 s54, s54, s4
    s_mov_b32 m0, s54
    s_add_u32 s54, s54, 16384
    buffer_load_dwordx4 v201, s[36:39], s49 offen offset:0 lds
    buffer_load_dwordx4 v202, s[36:39], s49 offen offset:1024 lds
    buffer_load_dwordx4 v203, s[36:39], s49 offen offset:2048 lds
    buffer_load_dwordx4 v204, s[36:39], s49 offen offset:3072 lds
    s_add_u32 s49, s49, 131072
    s_cmp_ge_u32 s54, 98304
    s_cselect_b32 s4, 98304, 0
    s_sub_u32 s54, s54, s4
    s_mov_b32 m0, s54
    s_add_u32 s54, s54, 16384
    buffer_load_dwordx4 v201, s[36:39], s49 offen offset:0 lds
    buffer_load_dwordx4 v202, s[36:39], s49 offen offset:1024 lds
    buffer_load_dwordx4 v203, s[36:39], s49 offen offset:2048 lds
    buffer_load_dwordx4 v204, s[36:39], s49 offen offset:3072 lds
    s_add_u32 s49, s49, 131072
    s_cmp_ge_u32 s54, 98304
    s_cselect_b32 s4, 98304, 0
    s_sub_u32 s54, s54, s4
    s_barrier
    s_add_u32 m0, s50, 98304
    s_add_u32 s50, s50, 16384
    buffer_load_dwordx4 v2, s[24:27], s48 offen offset:0 sc1 lds
    buffer_load_dwordx4 v2, s[24:27], s48 offen offset:1024 sc1 lds
    buffer_load_dwordx4 v2, s[24:27], s48 offen offset:2048 sc1 lds
    buffer_load_dwordx4 v2, s[24:27], s48 offen offset:3072 sc1 lds
    s_add_u32 s48, s48, 4096
    s_and_b32 s50, s50, 65535
    s_add_u32 m0, s50, 98304
    s_add_u32 s50, s50, 16384
    buffer_load_dwordx4 v2, s[24:27], s48 offen offset:0 sc1 lds
    buffer_load_dwordx4 v2, s[24:27], s48 offen offset:1024 sc1 lds
    buffer_load_dwordx4 v2, s[24:27], s48 offen offset:2048 sc1 lds
    buffer_load_dwordx4 v2, s[24:27], s48 offen offset:3072 sc1 lds
    s_add_u32 s48, s48, 4096
    s_and_b32 s50, s50, 65535
    s_add_u32 m0, s50, 98304
    s_add_u32 s50, s50, 16384
    buffer_load_dwordx4 v2, s[24:27], s48 offen offset:0 sc1 lds
    buffer_load_dwordx4 v2, s[24:27], s48 offen offset:1024 sc1 lds
    buffer_load_dwordx4 v2, s[24:27], s48 offen offset:2048 sc1 lds
    buffer_load_dwordx4 v2, s[24:27], s48 offen offset:3072 sc1 lds
    s_add_u32 s48, s48, 4096
    s_and_b32 s50, s50, 65535
    s_add_u32 m0, s50, 98304
    s_add_u32 s50, s50, 16384
    buffer_load_dwordx4 v2, s[24:27], s48 offen offset:0 sc1 lds
    buffer_load_dwordx4 v2, s[24:27], s48 offen offset:1024 sc1 lds
    buffer_load_dwordx4 v2, s[24:27], s48 offen offset:2048 sc1 lds
    buffer_load_dwordx4 v2, s[24:27], s48 offen offset:3072 sc1 lds
    s_add_u32 s48, s48, 4096
    s_and_b32 s50, s50, 65535
    s_waitcnt vmcnt(12)
    s_barrier
    s_waitcnt vmcnt(8)
    s_barrier
    s_add_u32 m0, s50, 98304
    s_add_u32 s50, s50, 16384
    buffer_load_dwordx4 v2, s[24:27], s48 offen offset:0 sc1 lds
    buffer_load_dwordx4 v2, s[24:27], s48 offen offset:1024 sc1 lds
    buffer_load_dwordx4 v2, s[24:27], s48 offen offset:2048 sc1 lds
    buffer_load_dwordx4 v2, s[24:27], s48 offen offset:3072 sc1 lds
    s_add_u32 s48, s48, 4096
    s_and_b32 s50, s50, 65535
    s_add_u32 m0, s54, 0
    s_nop 0
    buffer_load_dwordx4 v201, s[36:39], s49 offen offset:0 lds
    s_add_u32 m0, s54, 0
    s_nop 0
    buffer_load_dwordx4 v202, s[36:39], s49 offen offset:1024 lds
    s_add_u32 m0, s54, 0
    s_nop 0
    buffer_load_dwordx4 v203, s[36:39], s49 offen offset:2048 lds
    s_waitcnt vmcnt(11)
    s_barrier
    s_add_u32 m0, s50, 98304
    s_add_u32 s50, s50, 16384
    buffer_load_dwordx4 v2, s[24:27], s48 offen offset:0 sc1 lds
    buffer_load_dwordx4 v2, s[24:27], s48 offen offset:1024 sc1 lds
    buffer_load_dwordx4 v2, s[24:27], s48 offen offset:2048 sc1 lds
    buffer_load_dwordx4 v2, s[24:27], s48 offen offset:3072 sc1 lds
    s_add_u32 s48, s48, 4096
    s_and_b32 s50, s50, 65535
    s_add_u32 m0, s54, 0
    s_nop 0
    buffer_load_dwordx4 v204, s[36:39], s49 offen offset:3072 lds
    s_add_u32 s49, s49, 131072
    s_add_u32 m0, s54, 16384
    s_nop 0
    buffer_load_dwordx4 v201, s[36:39], s49 offen offset:0 lds
    s_add_u32 m0, s54, 16384
    s_nop 0
    buffer_load_dwordx4 v202, s[36:39], s49 offen offset:1024 lds
    s_waitcnt vmcnt(14)
    s_barrier
    s_add_u32 m0, s50, 98304
    s_add_u32 s50, s50, 16384
    buffer_load_dwordx4 v2, s[24:27], s48 offen offset:0 sc1 lds
    buffer_load_dwordx4 v2, s[24:27], s48 offen offset:1024 sc1 lds
    buffer_load_dwordx4 v2, s[24:27], s48 offen offset:2048 sc1 lds
    buffer_load_dwordx4 v2, s[24:27], s48 offen offset:3072 sc1 lds
    s_add_u32 s48, s48, 4096
    s_and_b32 s50, s50, 65535
    s_add_u32 m0, s54, 16384
    s_nop 0
    buffer_load_dwordx4 v203, s[36:39], s49 offen offset:2048 lds
    s_add_u32 m0, s54, 16384
    s_nop 0
    buffer_load_dwordx4 v204, s[36:39], s49 offen offset:3072 lds
    s_add_u32 s49, s49, 131072
    s_add_u32 m0, s54, 32768
    s_nop 0
    buffer_load_dwordx4 v201, s[36:39], s49 offen offset:0 lds
    s_waitcnt vmcnt(17)
    s_barrier
    s_add_u32 m0, s50, 98304
    s_add_u32 s50, s50, 16384
    buffer_load_dwordx4 v2, s[24:27], s48 offen offset:0 sc1 lds
    buffer_load_dwordx4 v2, s[24:27], s48 offen offset:1024 sc1 lds
    buffer_load_dwordx4 v2, s[24:27], s48 offen offset:2048 sc1 lds
    buffer_load_dwordx4 v2, s[24:27], s48 offen offset:3072 sc1 lds
    s_add_u32 s48, s48, 4096
    s_and_b32 s50, s50, 65535
    s_add_u32 m0, s54, 32768
    s_nop 0
    buffer_load_dwordx4 v202, s[36:39], s49 offen offset:1024 lds
    s_add_u32 m0, s54, 32768
    s_nop 0
    buffer_load_dwordx4 v203, s[36:39], s49 offen offset:2048 lds
    s_add_u32 m0, s54, 32768
    s_nop 0
    buffer_load_dwordx4 v204, s[36:39], s49 offen offset:3072 lds
    s_add_u32 s49, s49, 131072
    s_waitcnt vmcnt(17)
    s_barrier
    s_add_u32 m0, s50, 98304
    s_add_u32 s50, s50, 16384
    buffer_load_dwordx4 v2, s[24:27], s48 offen offset:0 sc1 lds
    buffer_load_dwordx4 v2, s[24:27], s48 offen offset:1024 sc1 lds
    buffer_load_dwordx4 v2, s[24:27], s48 offen offset:2048 sc1 lds
    buffer_load_dwordx4 v2, s[24:27], s48 offen offset:3072 sc1 lds
    s_add_u32 s48, s48, 4096
    s_and_b32 s50, s50, 65535
    s_add_u32 m0, s54, 49152
    s_nop 0
    buffer_load_dwordx4 v201, s[36:39], s49 offen offset:0 lds
    s_add_u32 m0, s54, 49152
    s_nop 0
    buffer_load_dwordx4 v202, s[36:39], s49 offen offset:1024 lds
    s_add_u32 m0, s54, 49152
    s_nop 0
    buffer_load_dwordx4 v203, s[36:39], s49 offen offset:2048 lds
    s_waitcnt vmcnt(17)
    s_barrier
    s_add_u32 m0, s50, 98304
    s_add_u32 s50, s50, 16384
    buffer_load_dwordx4 v2, s[24:27], s48 offen offset:0 sc1 lds
    buffer_load_dwordx4 v2, s[24:27], s48 offen offset:1024 sc1 lds
    buffer_load_dwordx4 v2, s[24:27], s48 offen offset:2048 sc1 lds
    buffer_load_dwordx4 v2, s[24:27], s48 offen offset:3072 sc1 lds
    s_add_u32 s48, s48, 4096
    s_and_b32 s50, s50, 65535
    s_add_u32 m0, s54, 49152
    s_nop 0
    buffer_load_dwordx4 v204, s[36:39], s49 offen offset:3072 lds
    s_add_u32 s49, s49, 131072
    s_add_u32 m0, s54, 65536
    s_nop 0
    buffer_load_dwordx4 v201, s[36:39], s49 offen offset:0 lds
    s_add_u32 m0, s54, 65536
    s_nop 0
    buffer_load_dwordx4 v202, s[36:39], s49 offen offset:1024 lds
    s_waitcnt vmcnt(17)
    s_barrier
    s_add_u32 m0, s50, 98304
    s_add_u32 s50, s50, 16384
    buffer_load_dwordx4 v2, s[24:27], s48 offen offset:0 sc1 lds
    buffer_load_dwordx4 v2, s[24:27], s48 offen offset:1024 sc1 lds
    buffer_load_dwordx4 v2, s[24:27], s48 offen offset:2048 sc1 lds
    buffer_load_dwordx4 v2, s[24:27], s48 offen offset:3072 sc1 lds
    s_add_u32 s48, s48, 4096
    s_and_b32 s50, s50, 65535
    s_add_u32 m0, s54, 65536
    s_nop 0
    buffer_load_dwordx4 v203, s[36:39], s49 offen offset:2048 lds
    s_add_u32 m0, s54, 65536
    s_nop 0
    buffer_load_dwordx4 v204, s[36:39], s49 offen offset:3072 lds
    s_add_u32 s49, s49, 131072
    s_add_u32 m0, s54, 81920
    s_nop 0
    buffer_load_dwordx4 v201, s[36:39], s49 offen offset:0 lds
    s_waitcnt vmcnt(17)
    s_barrier
    s_add_u32 m0, s50, 98304
    s_add_u32 s50, s50, 16384
    buffer_load_dwordx4 v2, s[24:27], s48 offen offset:0 sc1 lds
    buffer_load_dwordx4 v2, s[24:27], s48 offen offset:1024 sc1 lds
    buffer_load_dwordx4 v2, s[24:27], s48 offen offset:2048 sc1 lds
    buffer_load_dwordx4 v2, s[24:27], s48 offen offset:3072 sc1 lds
    s_add_u32 s48, s48, 4096
    s_and_b32 s50, s50, 65535
    s_add_u32 m0, s54, 81920
    s_nop 0
    buffer_load_dwordx4 v202, s[36:39], s49 offen offset:1024 lds
    s_add_u32 m0, s54, 81920
    s_nop 0
    buffer_load_dwordx4 v203, s[36:39], s49 offen offset:2048 lds
    s_add_u32 m0, s54, 81920
    s_nop 0
    buffer_load_dwordx4 v204, s[36:39], s49 offen offset:3072 lds
    s_add_u32 s49, s49, 131072
    s_waitcnt vmcnt(16)
    s_barrier
    s_add_u32 m0, s50, 98304
    s_add_u32 s50, s50, 16384
    buffer_load_dwordx4 v2, s[24:27], s48 offen offset:0 sc1 lds
    buffer_load_dwordx4 v2, s[24:27], s48 offen offset:1024 sc1 lds
    buffer_load_dwordx4 v2, s[24:27], s48 offen offset:2048 sc1 lds
    buffer_load_dwordx4 v2, s[24:27], s48 offen offset:3072 sc1 lds
    s_add_u32 s48, s48, 4096
    s_and_b32 s50, s50, 65535
    s_add_u32 m0, s54, 0
    s_nop 0
    buffer_load_dwordx4 v201, s[36:39], s49 offen offset:0 lds
    s_add_u32 m0, s54, 0
    s_nop 0
    buffer_load_dwordx4 v202, s[36:39], s49 offen offset:1024 lds
    s_add_u32 m0, s54, 0
    s_nop 0
    buffer_load_dwordx4 v203, s[36:39], s49 offen offset:2048 lds
    s_add_u32 m0, s54, 0
    s_nop 0
    buffer_load_dwordx4 v204, s[36:39], s49 offen offset:3072 lds
    s_add_u32 s49, s49, 131072
    s_waitcnt vmcnt(16)
    s_barrier
    s_add_u32 m0, s50, 98304
    s_add_u32 s50, s50, 16384
    buffer_load_dwordx4 v2, s[24:27], s48 offen offset:0 sc1 lds
    buffer_load_dwordx4 v2, s[24:27], s48 offen offset:1024 sc1 lds
    buffer_load_dwordx4 v2, s[24:27], s48 offen offset:2048 sc1 lds
    buffer_load_dwordx4 v2, s[24:27], s48 offen offset:3072 sc1 lds
    s_add_u32 s48, s48, 4096
    s_and_b32 s50, s50, 65535
    s_add_u32 m0, s54, 16384
    s_nop 0
    buffer_load_dwordx4 v201, s[36:39], s49 offen offset:0 lds
    s_add_u32 m0, s54, 16384
    s_nop 0
    buffer_load_dwordx4 v202, s[36:39], s49 offen offset:1024 lds
    s_add_u32 m0, s54, 16384
    s_nop 0
    buffer_load_dwordx4 v203, s[36:39], s49 offen offset:2048 lds
    s_add_u32 m0, s54, 16384
    s_nop 0
    buffer_load_dwordx4 v204, s[36:39], s49 offen offset:3072 lds
    s_add_u32 s49, s49, 131072
    s_waitcnt vmcnt(16)
    s_barrier
    s_add_u32 m0, s50, 98304
    s_add_u32 s50, s50, 16384
    buffer_load_dwordx4 v2, s[24:27], s48 offen offset:0 sc1 lds
    buffer_load_dwordx4 v2, s[24:27], s48 offen offset:1024 sc1 lds
    buffer_load_dwordx4 v2, s[24:27], s48 offen offset:2048 sc1 lds
    buffer_load_dwordx4 v2, s[24:27], s48 offen offset:3072 sc1 lds
    s_add_u32 s48, s48, 4096
    s_and_b32 s50, s50, 65535
    s_add_u32 m0, s54, 32768
    s_nop 0
    buffer_load_dwordx4 v201, s[36:39], s49 offen offset:0 lds
    s_add_u32 m0, s54, 32768
    s_nop 0
    buffer_load_dwordx4 v202, s[36:39], s49 offen offset:1024 lds
    s_add_u32 m0, s54, 32768
    s_nop 0
    buffer_load_dwordx4 v203, s[36:39], s49 offen offset:2048 lds
    s_add_u32 m0, s54, 32768
    s_nop 0
    buffer_load_dwordx4 v204, s[36:39], s49 offen offset:3072 lds
    s_add_u32 s49, s49, 131072
    s_waitcnt vmcnt(16)
    s_barrier
    s_add_u32 m0, s50, 98304
    s_add_u32 s50, s50, 16384
    buffer_load_dwordx4 v2, s[24:27], s48 offen offset:0 sc1 lds
    buffer_load_dwordx4 v2, s[24:27], s48 offen offset:1024 sc1 lds
    buffer_load_dwordx4 v2, s[24:27], s48 offen offset:2048 sc1 lds
    buffer_load_dwordx4 v2, s[24:27], s48 offen offset:3072 sc1 lds
    s_add_u32 s48, s48, 4096
    s_and_b32 s50, s50, 65535
    s_add_u32 m0, s54, 49152
    s_nop 0
    buffer_load_dwordx4 v201, s[36:39], s49 offen offset:0 lds
    s_add_u32 m0, s54, 49152
    s_nop 0
    buffer_load_dwordx4 v202, s[36:39], s49 offen offset:1024 lds
    s_add_u32 m0, s54, 49152
    s_nop 0
    buffer_load_dwordx4 v203, s[36:39], s49 offen offset:2048 lds
    s_add_u32 m0, s54, 49152
    s_nop 0
    buffer_load_dwordx4 v204, s[36:39], s49 offen offset:3072 lds
    s_add_u32 s49, s49, 131072
    s_waitcnt vmcnt(16)
    s_barrier
    s_waitcnt vmcnt(8)
    s_barrier
    s_waitcnt vmcnt(0)
    s_barrier
    s_endpgm
L_k2_slow:
    s_waitcnt vmcnt(0)
    v_mov_b32 v3, 0xff800000
    s_mov_b32 s23, s3
    s_mov_b32 s29, 64
L_k2_slow1:
    buffer_load_dwordx4 v[24:27], v2, s[24:27], s23 offen sc1
    buffer_load_dwordx4 v[28:31], v2, s[24:27], s23 offen offset:1024 sc1
    s_waitcnt vmcnt(0)
    v_mfma_f32_32x32x16_bf16 v[104:119], v[24:27], v[8:11], 0
    v_mfma_f32_32x32x16_bf16 v[104:119], v[28:31], v[12:15], v[104:119]
    s_nop 15
    v_max3_f32 v3, v3, v104, v105
    v_max3_f32 v3, v3, v106, v107
    v_max3_f32 v3, v3, v108, v109
    v_max3_f32 v3, v3, v110, v111
    v_max3_f32 v3, v3, v112, v113
    v_max3_f32 v3, v3, v114, v115
    v_max3_f32 v3, v3, v116, v117
    v_max3_f32 v3, v3, v118, v119
    s_add_u32 s23, s23, 2048
    s_sub_u32 s29, s29, 1
    s_cmp_lg_u32 s29, 0
    s_cbranch_scc1 L_k2_slow1
    v_mov_b32 v4, v3
    s_nop 1
    v_permlane32_swap_b32 v3, v4
    v_max_f32 v3, v3, v4
    v_sub_f32 v56, 0, v3
    v_mov_b32 v72, 0
    v_sub_f32 v57, 0, v3
    v_mov_b32 v73, 0
    v_sub_f32 v58, 0, v3
    v_mov_b32 v74, 0
    v_sub_f32 v59, 0, v3
    v_mov_b32 v75, 0
    v_sub_f32 v60, 0, v3
    v_mov_b32 v76, 0
    v_sub_f32 v61, 0, v3
    v_mov_b32 v77, 0
    v_sub_f32 v62, 0, v3
    v_mov_b32 v78, 0
    v_sub_f32 v63, 0, v3
    v_mov_b32 v79, 0
    v_sub_f32 v64, 0, v3
    v_mov_b32 v80, 0
    v_sub_f32 v65, 0, v3
    v_mov_b32 v81, 0
    v_sub_f32 v66, 0, v3
    v_mov_b32 v82, 0
    v_sub_f32 v67, 0, v3
    v_mov_b32 v83, 0
    v_sub_f32 v68, 0, v3
    v_mov_b32 v84, 0
    v_sub_f32 v69, 0, v3
    v_mov_b32 v85, 0
    v_sub_f32 v70, 0, v3
    v_mov_b32 v86, 0
    v_sub_f32 v71, 0, v3
    v_mov_b32 v87, 0
    v_mov_b32 v52, 0
    v_mov_b32 v53, 0
    v_mov_b32 v54, 0
    v_mov_b32 v55, 0
    s_mov_b32 s23, s3
    s_mov_b32 s29, 64
L_k2_slow2:
    buffer_load_dwordx4 v[24:27], v2, s[24:27], s23 offen sc1
    buffer_load_dwordx4 v[28:31], v2, s[24:27], s23 offen offset:1024 sc1
    s_add_u32 s4, s23, 4194304
    buffer_load_dwordx4 v[32:35], v2, s[24:27], s4 offen sc1
    buffer_load_dwordx4 v[36:39], v2, s[24:27], s4 offen offset:1024 sc1
    s_waitcnt vmcnt(0)
    v_mfma_f32_32x32x16_bf16 v[104:119], v[24:27], v[8:11], v[56:71]
    v_mfma_f32_32x32x16_bf16 v[104:119], v[28:31], v[12:15], v[104:119]
    s_nop 15
    v_exp_f32 v104, v104
    v_exp_f32 v105, v105
    v_exp_f32 v106, v106
    v_exp_f32 v107, v107
    v_exp_f32 v108, v108
    v_exp_f32 v109, v109
    v_exp_f32 v110, v110
    v_exp_f32 v111, v111
    v_exp_f32 v112, v112
    v_exp_f32 v113, v113
    v_exp_f32 v114, v114
    v_exp_f32 v115, v115
    v_exp_f32 v116, v116
    v_exp_f32 v117, v117
    v_exp_f32 v118, v118
    v_exp_f32 v119, v119
    s_nop 0
    v_cvt_pk_bf16_f32 v40, v104, v105
    v_cvt_pk_bf16_f32 v41, v106, v107
    v_cvt_pk_bf16_f32 v42, v108, v109
    v_cvt_pk_bf16_f32 v43, v110, v111
    v_cvt_pk_bf16_f32 v44, v112, v113
    v_cvt_pk_bf16_f32 v45, v114, v115
    v_cvt_pk_bf16_f32 v46, v116, v117
    v_cvt_pk_bf16_f32 v47, v118, v119
    s_nop 1
    v_mfma_f32_32x32x16_bf16 v[72:87], v[32:35], v[40:43], v[72:87]
    v_mfma_f32_32x32x16_bf16 v[72:87], v[36:39], v[44:47], v[72:87]
    v_smfmac_f32_16x16x64_bf16 v[52:55], v[48:51], v[40:47], v185
    s_add_u32 s23, s23, 2048
    s_sub_u32 s29, s29, 1
    s_cmp_lg_u32 s29, 0
    s_cbranch_scc1 L_k2_slow2
    s_nop 15
    s_branch L_k2_fin
L_code_end:
.section .rodata,"a"
.p2align 6
.amdhsa_kernel concat_heads__linear_attn_block__softmax_full_mha__prompt_kernel
  .amdhsa_next_free_vgpr 237
  .amdhsa_next_free_sgpr 102
  .amdhsa_accum_offset 240
  .amdhsa_group_segment_fixed_size 0
  .amdhsa_kernarg_size 72
  .amdhsa_user_sgpr_count 2
  .amdhsa_user_sgpr_kernarg_segment_ptr 1
  .amdhsa_system_sgpr_workgroup_id_x 1
  .amdhsa_float_denorm_mode_32 3
.end_amdhsa_kernel
```
